```python
import torch

def _softmax(x, axis=-1):
    return torch.softmax(x, dim=axis)

def _gelu(x):
    return torch.nn.functional.gelu(x, approximate='tanh')

def _silu(x):
    return torch.nn.functional.silu(x)

def _sigmoid(x):
    return torch.sigmoid(x)

def _layernorm(x, axis=-1, eps=1e-05):
    m = x.mean(dim=axis, keepdim=True)
    v = x.var(dim=axis, keepdim=True, unbiased=False)
    return (x - m) / torch.sqrt(v + eps)

def _scatter_add(tgt, idx, src, axis=0):
    return tgt.clone().index_add_(axis, idx, src)

def _segment_sum(src, seg, n):
    out = torch.zeros((n,) + src.shape[1:], dtype=src.dtype)
    return out.index_add_(0, seg, src)

def _pad(x, pw):
    flat = tuple((v for pair in reversed(pw) for v in pair))
    return torch.nn.functional.pad(x, flat)
kernel_name = 'adaLN_cond__compressed_kv_cla__glu_gated_reglu__prompt'

def setup_inputs():

    _w = lambda a: (lambda t: t.to(torch.bfloat16) if t.is_floating_point() else t)(torch.as_tensor(a))

    def _A_setup():
        B, H, Sq, Sk, D, M = (1, 32, 2048, 2048, 128, 512)
        Dc = 4 * D
        return {'x': _w((lambda *s: torch.randn(*s, dtype=torch.bfloat16) * 0.05)(B, Sq, M)), 'c_kv': _w((lambda *s: torch.randn(*s, dtype=torch.bfloat16) * 0.8)(B, Sk, Dc)), 'w_q': _w((lambda *s: torch.randn(*s, dtype=torch.bfloat16) * 1.6)(M, H, D) * M ** (-0.5)), 'w_uk': _w((lambda *s: torch.randn(*s, dtype=torch.bfloat16) * 1.6)(Dc, H, D) * Dc ** (-0.5)), 'w_uv': _w((lambda *s: torch.randn(*s, dtype=torch.bfloat16) * 0.8)(Dc, H, D) * Dc ** (-0.5)), 'w_o': _w((lambda *s: torch.randn(*s, dtype=torch.bfloat16) * 0.8)(H, D, M) * (H * D) ** (-0.5))}
    _A_in = _A_setup()

    def _B_setup():
        B, S, D, F = (1, 2048, 512, 1792)
        return {'x': _w((lambda *s: torch.randn(*s, dtype=torch.bfloat16) * 0.05)(B, S, D)), 'W_gate': _w((lambda *s: torch.randn(*s, dtype=torch.bfloat16) * 0.4)(D, F) * (2.0 / D) ** 0.5), 'W_up': _w((lambda *s: torch.randn(*s, dtype=torch.bfloat16) * 0.4)(D, F) * (2.0 / D) ** 0.5), 'W_down': _w((lambda *s: torch.randn(*s, dtype=torch.bfloat16) * 0.4)(F, D) * (1.0 / F) ** 0.5)}
    _B_in = _B_setup()
    return {'A_x': _A_in['x'], 'A_c_kv': _A_in['c_kv'], 'A_w_q': _A_in['w_q'], 'A_w_uk': _A_in['w_uk'], 'A_w_uv': _A_in['w_uv'], 'A_w_o': _A_in['w_o'], 'B_x': _B_in['x'], 'B_W_gate': _B_in['W_gate'], 'B_W_up': _B_in['W_up'], 'B_W_down': _B_in['W_down'], 'c': _w((lambda *s: torch.randn(*s, dtype=torch.bfloat16) * 0.1)(1, 512) * 8.0), 'w_mod': _w((lambda *s: torch.randn(*s, dtype=torch.bfloat16) * 0.1)(512, 6 * 512) * 512 ** (-0.5) * 8.0)}

def reference(A_x, A_c_kv, A_w_q, A_w_uk, A_w_uv, A_w_o, B_x, B_W_gate, B_W_up, B_W_down, c, w_mod):

    def _A_ref(x, c_kv, w_q, w_uk, w_uv, w_o):
        B, Sq, M = (x.shape[0], x.shape[1], x.shape[2])
        Sk = c_kv.shape[1]
        H, D = (w_q.shape[1], w_q.shape[2])
        q = torch.einsum('bqm,mhd->bhqd', x, w_q)
        k = torch.einsum('bkc,chd->bhkd', c_kv, w_uk)
        v = torch.einsum('bkc,chd->bhkd', c_kv, w_uv)
        scores = torch.einsum('bhqd,bhkd->bhqk', q, k) * D ** (-0.5)
        off = Sk - Sq
        qi = torch.arange(Sq)[:, None]
        kj = torch.arange(Sk)[None, :]
        cmask = kj <= qi + off
        scores = torch.where(cmask[None, None], scores, -1000000000.0)
        p = _softmax(scores, axis=-1)
        ctx = torch.einsum('bhqk,bhkd->bhqd', p, v)
        return torch.einsum('bhqd,hdm->bqm', ctx, w_o)

    def _B_ref(x, W_gate, W_up, W_down):
        gate = torch.einsum('bsd,df->bsf', x, W_gate)
        up = torch.einsum('bsd,df->bsf', x, W_up)
        gate = gate * (lambda x, dt: x.to(dt))(gate > 0, gate.dtype)
        h = gate * up
        return torch.einsum('bsf,fd->bsd', h, W_down)
    x = A_x
    mod = (_silu(c) @ w_mod).reshape(c.shape[0], 6, 1, -1)
    sa, ca, ga, sb, cb, gb = (mod[:, 0].clone(), mod[:, 1].clone(), mod[:, 2].clone(), mod[:, 3].clone(), mod[:, 4].clone(), mod[:, 5].clone())
    h = _layernorm(x, axis=-1) * (1 + ca) + sa
    x = x + ga * _A_ref(h, A_c_kv, A_w_q, A_w_uk, A_w_uv, A_w_o)
    h = _layernorm(x, axis=-1) * (1 + cb) + sb
    x = x + gb * _B_ref(h, B_W_gate, B_W_up, B_W_down)
    return x
```

```asm
; @launch kernel=mod_kernel grid=(96,1,1) block=(512,1,1) lds=18432
; @launch kernel=kvprep_kernel grid=(256,1,1) block=(512,1,1) lds=131072
; @launch kernel=attn_kernel grid=(256,1,1) block=(512,1,1) lds=163840
; @launch kernel=oproj_kernel grid=(256,1,1) block=(512,1,1) lds=131072
; @launch kernel=ln2_kernel grid=(256,1,1) block=(512,1,1) lds=512
; @launch kernel=glu_kernel grid=(224,1,1) block=(512,1,1) lds=147456
; @launch kernel=down_kernel grid=(256,1,1) block=(512,1,1) lds=131072
.amdgcn_target "amdgcn-amd-amdhsa--gfx950"
.text
.globl mod_kernel
.p2align 8
.type mod_kernel,@function
mod_kernel:
    s_cmp_ge_u32 s2, 96
    s_cbranch_scc1 mod_kernel_end
    s_cmp_lt_u32 s2, 96
    s_cbranch_scc1 mod_kernel_main
    s_load_dwordx4 s[4:7], s[0:1], 0
    s_load_dwordx4 s[8:11], s[0:1], 24
    s_sub_u32 s35, s2, 96
    v_lshlrev_b32 v1, 4, v0
    s_waitcnt lgkmcnt(0)
    s_cmp_lt_u32 s35, 64
    s_cselect_b64 s[12:13], s[8:9], s[10:11]
    s_cmp_lt_u32 s35, 160
    s_cselect_b64 s[14:15], s[6:7], s[4:5]
    s_cmp_lt_u32 s35, 128
    s_cselect_b64 s[16:17], s[12:13], s[14:15]
    s_cselect_b32 s36, 63, 31
    s_cselect_b32 s18, 4, 2
    s_lshl_b32 s18, s18, 20
    s_mov_b32 s19, 0x00020000
    s_and_b32 s35, s35, s36
    s_lshl_b32 s35, s35, 16
    buffer_load_dwordx4 v[16:19], v1, s[16:19], s35 offen
    s_add_u32 s35, s35, 8192
    buffer_load_dwordx4 v[20:23], v1, s[16:19], s35 offen
    s_add_u32 s35, s35, 8192
    buffer_load_dwordx4 v[24:27], v1, s[16:19], s35 offen
    s_add_u32 s35, s35, 8192
    buffer_load_dwordx4 v[28:31], v1, s[16:19], s35 offen
    s_add_u32 s35, s35, 8192
    buffer_load_dwordx4 v[32:35], v1, s[16:19], s35 offen
    s_add_u32 s35, s35, 8192
    buffer_load_dwordx4 v[36:39], v1, s[16:19], s35 offen
    s_add_u32 s35, s35, 8192
    buffer_load_dwordx4 v[40:43], v1, s[16:19], s35 offen
    s_add_u32 s35, s35, 8192
    buffer_load_dwordx4 v[44:47], v1, s[16:19], s35 offen
    s_add_u32 s35, s35, 8192
    s_waitcnt vmcnt(0)
    s_endpgm
mod_kernel_main:
    s_load_dwordx2 s[6:7], s[0:1], 80
    s_load_dwordx2 s[8:9], s[0:1], 88
    s_load_dwordx2 s[10:11], s[0:1], 112
    v_and_b32 v1, 3, v0
    v_lshrrev_b32 v2, 2, v0
    s_mov_b32 s35, 24576
    v_mul_lo_u32 v3, v2, s35
    v_lshl_add_u32 v3, v1, 4, v3
    v_lshlrev_b32 v4, 3, v2
    s_lshl_b32 s36, s2, 6
    s_waitcnt lgkmcnt(0)
    s_mov_b32 s16, s6
    s_mov_b32 s17, s7
    s_mov_b32 s18, 0x400
    s_mov_b32 s19, 0x00020000
    s_mov_b32 s20, s8
    s_mov_b32 s21, s9
    s_mov_b32 s22, 0x300000
    s_mov_b32 s23, 0x00020000
    s_mov_b32 s24, s10
    s_mov_b32 s25, s11
    s_mov_b32 s26, 0x3000
    s_mov_b32 s27, 0x00020000
    buffer_load_dwordx2 v[8:9], v4, s[16:19], 0 offen
    s_add_u32 s35, s36, 0
    buffer_load_dwordx4 v[16:19], v3, s[20:23], s35 offen
    s_add_u32 s35, s36, 6144
    buffer_load_dwordx4 v[20:23], v3, s[20:23], s35 offen
    s_add_u32 s35, s36, 12288
    buffer_load_dwordx4 v[24:27], v3, s[20:23], s35 offen
    s_add_u32 s35, s36, 18432
    buffer_load_dwordx4 v[28:31], v3, s[20:23], s35 offen
    s_waitcnt vmcnt(4)
    v_lshlrev_b32 v40, 16, v8
    v_and_b32 v41, 0xffff0000, v8
    v_lshlrev_b32 v42, 16, v9
    v_and_b32 v43, 0xffff0000, v9
    v_mul_f32 v44, 0xbfb8aa3b, v40
    v_mul_f32 v45, 0xbfb8aa3b, v41
    v_mul_f32 v46, 0xbfb8aa3b, v42
    v_mul_f32 v47, 0xbfb8aa3b, v43
    v_exp_f32 v44, v44
    v_exp_f32 v45, v45
    v_exp_f32 v46, v46
    v_exp_f32 v47, v47
    v_add_f32 v44, 1.0, v44
    v_add_f32 v45, 1.0, v45
    v_add_f32 v46, 1.0, v46
    v_add_f32 v47, 1.0, v47
    v_rcp_f32 v44, v44
    v_rcp_f32 v45, v45
    v_rcp_f32 v46, v46
    v_rcp_f32 v47, v47
    v_mul_f32 v40, v40, v44
    v_mul_f32 v41, v41, v45
    v_mul_f32 v42, v42, v46
    v_mul_f32 v43, v43, v47
    v_cvt_pk_bf16_f32 v40, v40, v40
    v_lshlrev_b32 v40, 16, v40
    v_cvt_pk_bf16_f32 v41, v41, v41
    v_lshlrev_b32 v41, 16, v41
    v_cvt_pk_bf16_f32 v42, v42, v42
    v_lshlrev_b32 v42, 16, v42
    v_cvt_pk_bf16_f32 v43, v43, v43
    v_lshlrev_b32 v43, 16, v43
    v_mov_b32 v48, 0
    v_mov_b32 v49, 0
    v_mov_b32 v50, 0
    v_mov_b32 v51, 0
    v_mov_b32 v52, 0
    v_mov_b32 v53, 0
    v_mov_b32 v54, 0
    v_mov_b32 v55, 0
    v_lshlrev_b32 v6, 5, v0
    s_waitcnt vmcnt(0)
    v_lshlrev_b32 v14, 16, v16
    v_fmac_f32 v48, v14, v40
    v_and_b32 v14, 0xffff0000, v16
    v_fmac_f32 v49, v14, v40
    v_lshlrev_b32 v14, 16, v17
    v_fmac_f32 v50, v14, v40
    v_and_b32 v14, 0xffff0000, v17
    v_fmac_f32 v51, v14, v40
    v_lshlrev_b32 v14, 16, v18
    v_fmac_f32 v52, v14, v40
    v_and_b32 v14, 0xffff0000, v18
    v_fmac_f32 v53, v14, v40
    v_lshlrev_b32 v14, 16, v19
    v_fmac_f32 v54, v14, v40
    v_and_b32 v14, 0xffff0000, v19
    v_fmac_f32 v55, v14, v40
    v_lshlrev_b32 v14, 16, v20
    v_fmac_f32 v48, v14, v41
    v_and_b32 v14, 0xffff0000, v20
    v_fmac_f32 v49, v14, v41
    v_lshlrev_b32 v14, 16, v21
    v_fmac_f32 v50, v14, v41
    v_and_b32 v14, 0xffff0000, v21
    v_fmac_f32 v51, v14, v41
    v_lshlrev_b32 v14, 16, v22
    v_fmac_f32 v52, v14, v41
    v_and_b32 v14, 0xffff0000, v22
    v_fmac_f32 v53, v14, v41
    v_lshlrev_b32 v14, 16, v23
    v_fmac_f32 v54, v14, v41
    v_and_b32 v14, 0xffff0000, v23
    v_fmac_f32 v55, v14, v41
    v_lshlrev_b32 v14, 16, v24
    v_fmac_f32 v48, v14, v42
    v_and_b32 v14, 0xffff0000, v24
    v_fmac_f32 v49, v14, v42
    v_lshlrev_b32 v14, 16, v25
    v_fmac_f32 v50, v14, v42
    v_and_b32 v14, 0xffff0000, v25
    v_fmac_f32 v51, v14, v42
    v_lshlrev_b32 v14, 16, v26
    v_fmac_f32 v52, v14, v42
    v_and_b32 v14, 0xffff0000, v26
    v_fmac_f32 v53, v14, v42
    v_lshlrev_b32 v14, 16, v27
    v_fmac_f32 v54, v14, v42
    v_and_b32 v14, 0xffff0000, v27
    v_fmac_f32 v55, v14, v42
    v_lshlrev_b32 v14, 16, v28
    v_fmac_f32 v48, v14, v43
    v_and_b32 v14, 0xffff0000, v28
    v_fmac_f32 v49, v14, v43
    v_lshlrev_b32 v14, 16, v29
    v_fmac_f32 v50, v14, v43
    v_and_b32 v14, 0xffff0000, v29
    v_fmac_f32 v51, v14, v43
    v_lshlrev_b32 v14, 16, v30
    v_fmac_f32 v52, v14, v43
    v_and_b32 v14, 0xffff0000, v30
    v_fmac_f32 v53, v14, v43
    v_lshlrev_b32 v14, 16, v31
    v_fmac_f32 v54, v14, v43
    v_and_b32 v14, 0xffff0000, v31
    v_fmac_f32 v55, v14, v43
    ds_write_b128 v6, v[48:51]
    ds_write_b128 v6, v[52:55] offset:16
    v_and_b32 v6, 31, v0
    v_lshrrev_b32 v7, 5, v0
    v_lshlrev_b32 v9, 2, v6
    v_lshl_add_u32 v8, v7, 10, v9
    s_waitcnt lgkmcnt(0)
    s_barrier
    ds_read_b32 v16, v8 offset:0
    ds_read_b32 v17, v8 offset:128
    ds_read_b32 v18, v8 offset:256
    ds_read_b32 v19, v8 offset:384
    ds_read_b32 v20, v8 offset:512
    ds_read_b32 v21, v8 offset:640
    ds_read_b32 v22, v8 offset:768
    ds_read_b32 v23, v8 offset:896
    s_waitcnt lgkmcnt(0)
    v_add_f32 v16, v16, v17
    v_add_f32 v16, v16, v18
    v_add_f32 v16, v16, v19
    v_add_f32 v16, v16, v20
    v_add_f32 v16, v16, v21
    v_add_f32 v16, v16, v22
    v_add_f32 v16, v16, v23
    v_lshlrev_b32 v8, 2, v0
    ds_write_b32 v8, v16 offset:16384
    s_waitcnt lgkmcnt(0)
    s_barrier
    v_cmp_gt_u32 vcc, 32, v0
    s_and_saveexec_b64 s[38:39], vcc
    s_cbranch_execz mod_kernel_end
    ds_read_b32 v16, v9 offset:16384
    ds_read_b32 v17, v9 offset:16512
    ds_read_b32 v18, v9 offset:16640
    ds_read_b32 v19, v9 offset:16768
    ds_read_b32 v20, v9 offset:16896
    ds_read_b32 v21, v9 offset:17024
    ds_read_b32 v22, v9 offset:17152
    ds_read_b32 v23, v9 offset:17280
    ds_read_b32 v24, v9 offset:17408
    ds_read_b32 v25, v9 offset:17536
    ds_read_b32 v26, v9 offset:17664
    ds_read_b32 v27, v9 offset:17792
    ds_read_b32 v28, v9 offset:17920
    ds_read_b32 v29, v9 offset:18048
    ds_read_b32 v30, v9 offset:18176
    ds_read_b32 v31, v9 offset:18304
    s_waitcnt lgkmcnt(0)
    v_add_f32 v16, v16, v17
    v_add_f32 v16, v16, v18
    v_add_f32 v16, v16, v19
    v_add_f32 v16, v16, v20
    v_add_f32 v16, v16, v21
    v_add_f32 v16, v16, v22
    v_add_f32 v16, v16, v23
    v_add_f32 v16, v16, v24
    v_add_f32 v16, v16, v25
    v_add_f32 v16, v16, v26
    v_add_f32 v16, v16, v27
    v_add_f32 v16, v16, v28
    v_add_f32 v16, v16, v29
    v_add_f32 v16, v16, v30
    v_add_f32 v16, v16, v31
    v_cvt_pk_bf16_f32 v16, v16, v16
    v_lshlrev_b32 v16, 16, v16
    s_lshl_b32 s35, s2, 7
    buffer_store_dword v16, v9, s[24:27], s35 offen
mod_kernel_end:
    s_endpgm
.text
.globl kvprep_kernel
.p2align 8
.type kvprep_kernel,@function
kvprep_kernel:
    s_cmp_lt_u32 s2, 256
    s_cbranch_scc1 kvprep_kernel_gemm
    s_endpgm
kvprep_kernel_gemm:
    s_load_dwordx2 s[44:45], s[0:1], 8
    s_load_dwordx2 s[46:47], s[0:1], 24
    s_load_dwordx2 s[48:49], s[0:1], 32
    s_load_dwordx2 s[50:51], s[0:1], 112
    s_load_dwordx2 s[24:25], s[0:1], 16
    s_waitcnt lgkmcnt(0)
    s_mov_b32 s20, s24
    s_mov_b32 s21, s25
    s_mov_b32 s22, 0x400000
    s_mov_b32 s23, 0x00020000
    v_lshrrev_b32 v200, 6, v0
    v_and_b32 v201, 63, v0
    v_lshlrev_b32 v201, 4, v201
    v_lshl_add_u32 v200, v200, 13, v201
    s_lshr_b32 s26, s2, 3
    s_lshl_b32 s26, s26, 17
    s_and_b32 s27, s2, 7
    s_lshl_b32 s27, s27, 10
    s_add_u32 s26, s26, s27
    s_add_u32 s27, s26, 0x10000
    s_and_b32 s41, s2, 7
    s_lshl_b32 s41, s41, 2
    s_lshr_b32 s35, s2, 3
    s_and_b32 s35, s35, 3
    s_add_u32 s41, s41, s35
    s_lshr_b32 s40, s2, 5
    s_lshl_b32 s40, s40, 8
    s_mov_b32 s4, s44
    s_mov_b32 s5, s45
    s_mov_b32 s6, 0x200000
    s_mov_b32 s7, 0x00020000
    s_cmp_ge_u32 s41, 16
    s_cbranch_scc1 kvprep_kernel_v
    s_lshl_b32 s41, s41, 8
    s_mov_b32 s42, s41
    s_mov_b32 s8, s46
    s_mov_b32 s9, s47
    s_mov_b32 s10, 0x400000
    s_mov_b32 s11, 0x00020000
    s_add_u32 s16, s50, 0x1400000
    s_addc_u32 s17, s51, 0
    s_mov_b32 s18, 0x1000000
    s_mov_b32 s19, 0x00020000
    v_lshrrev_b32 v1, 6, v0
    v_and_b32 v188, 63, v0
    s_nop 0
    v_readfirstlane_b32 s28, v1
    s_lshl_b32 s31, s28, 10
    s_lshr_b32 s33, s28, 3
    s_and_b32 s34, s28, 7
    s_and_b32 s35, s34, 1
    s_lshr_b32 s36, s34, 1
    v_lshrrev_b32 v189, 3, v188
    s_mul_i32 s37, s28, 8
    v_add_u32 v189, s37, v189
    v_and_b32 v190, 7, v188
    v_lshrrev_b32 v191, 1, v189
    v_and_b32 v191, 7, v191
    v_xor_b32 v190, v190, v191
    v_lshlrev_b32 v190, 4, v190
    v_add_u32 v189, s40, v189
    s_mov_b32 s37, 1024
    v_mul_lo_u32 v189, v189, s37
    v_add_u32 v180, v189, v190
    v_add_u32 v181, 0x10000, v180
    v_add_u32 v182, 0x20000, v180
    v_add_u32 v183, 0x30000, v180
    v_lshrrev_b32 v189, 5, v188
    s_mul_i32 s37, s28, 2
    v_add_u32 v189, s37, v189
    v_and_b32 v190, 31, v188
    v_and_b32 v191, 3, v189
    v_lshlrev_b32 v191, 2, v191
    v_xor_b32 v190, v190, v191
    v_lshlrev_b32 v190, 4, v190
    s_mov_b32 s37, 8192
    v_mul_lo_u32 v189, v189, s37
    s_lshl_b32 s37, s41, 1
    v_add3_u32 v184, v189, v190, s37
    v_add_u32 v185, 0x20000, v184
    v_add_u32 v186, 0x40000, v184
    v_add_u32 v187, 0x60000, v184
    s_mov_b32 s43, 0
    s_lshr_b32 s49, s2, 3
    s_and_b32 s49, s49, 7
    s_mul_i32 s30, s49, 64
    s_add_u32 s30, s30, s43
    s_lshl_b32 s29, s30, 1
    s_mul_i32 s30, s30, 8192
    s_load_dwordx2 s[52:53], s[0:1], 0
    s_load_dwordx2 s[58:59], s[0:1], 112
    v_and_b32 v1, 63, v0
    v_lshlrev_b32 v2, 5, v1
    v_lshlrev_b32 v4, 4, v0
    s_lshl_b32 s80, s2, 13
    s_movk_i32 s81, 2048
    s_waitcnt lgkmcnt(0)
    s_mov_b32 s60, s52
    s_mov_b32 s61, s53
    s_mov_b32 s62, 0x200000
    s_mov_b32 s63, 0x00020000
    s_mov_b32 s72, s58
    s_mov_b32 s73, s59
    s_mov_b32 s74, 0x1000
    s_mov_b32 s75, 0x00020000
    s_add_u32 s76, s58, 0x100000
    s_addc_u32 s77, s59, 0
    s_mov_b32 s78, 0x200000
    s_mov_b32 s79, 0x00020000
    buffer_load_dwordx4 v[12:15], v4, s[60:63], s80 offen
    buffer_load_dwordx4 v[16:19], v2, s[72:75], 0 offen offset:0
    buffer_load_dwordx4 v[24:27], v2, s[72:75], s81 offen offset:0
    buffer_load_dwordx4 v[20:23], v2, s[72:75], 0 offen offset:16
    buffer_load_dwordx4 v[28:31], v2, s[72:75], s81 offen offset:16
    s_add_u32 s44, s31, 0x0
    s_add_u32 m0, s44, 0x0
    s_nop 0
    buffer_load_dwordx4 v180, s[4:7], s29 offen lds
    s_add_u32 m0, s44, 0x2000
    s_nop 0
    buffer_load_dwordx4 v181, s[4:7], s29 offen lds
    s_add_u32 m0, s44, 0x4000
    s_nop 0
    buffer_load_dwordx4 v182, s[4:7], s29 offen lds
    s_add_u32 m0, s44, 0x6000
    s_nop 0
    buffer_load_dwordx4 v183, s[4:7], s29 offen lds
    s_add_u32 m0, s44, 0x8000
    s_nop 0
    buffer_load_dwordx4 v184, s[8:11], s30 offen lds
    s_add_u32 m0, s44, 0xa000
    s_nop 0
    buffer_load_dwordx4 v185, s[8:11], s30 offen lds
    s_add_u32 m0, s44, 0xc000
    s_nop 0
    buffer_load_dwordx4 v186, s[8:11], s30 offen lds
    s_add_u32 m0, s44, 0xe000
    s_nop 0
    buffer_load_dwordx4 v187, s[8:11], s30 offen lds
    s_add_u32 s49, s49, 1
    s_cmp_ge_u32 s49, 8
    s_cselect_b32 s49, 0, s49
    s_mul_i32 s30, s49, 64
    s_add_u32 s30, s30, s43
    s_lshl_b32 s29, s30, 1
    s_mul_i32 s30, s30, 8192
    s_add_u32 s44, s31, 0x10000
    s_add_u32 m0, s44, 0x0
    s_nop 0
    buffer_load_dwordx4 v180, s[4:7], s29 offen lds
    s_add_u32 m0, s44, 0x2000
    s_nop 0
    buffer_load_dwordx4 v181, s[4:7], s29 offen lds
    s_add_u32 m0, s44, 0x4000
    s_nop 0
    buffer_load_dwordx4 v182, s[4:7], s29 offen lds
    s_add_u32 m0, s44, 0x6000
    s_nop 0
    buffer_load_dwordx4 v183, s[4:7], s29 offen lds
    s_add_u32 m0, s44, 0x8000
    s_nop 0
    buffer_load_dwordx4 v184, s[8:11], s30 offen lds
    s_add_u32 m0, s44, 0xa000
    s_nop 0
    buffer_load_dwordx4 v185, s[8:11], s30 offen lds
    s_add_u32 m0, s44, 0xc000
    s_nop 0
    buffer_load_dwordx4 v186, s[8:11], s30 offen lds
    s_add_u32 m0, s44, 0xe000
    s_nop 0
    buffer_load_dwordx4 v187, s[8:11], s30 offen lds
    s_add_u32 s49, s49, 1
    s_cmp_ge_u32 s49, 8
    s_cselect_b32 s49, 0, s49
    s_mul_i32 s30, s49, 64
    s_add_u32 s30, s30, s43
    s_lshl_b32 s29, s30, 1
    s_mul_i32 s30, s30, 8192
    s_add_u32 s44, s31, 0x0
    s_mov_b32 s45, 0x0
    s_mov_b32 s48, 0x10000
    s_waitcnt vmcnt(20)
    v_mov_b32 v10, 0
    v_mov_b32 v11, 0
    v_mov_b32 v6, 0x3f803f80
    v_dot2_f32_bf16 v10, v12, v6, v10
    v_dot2_f32_bf16 v11, v12, v12, v11
    v_dot2_f32_bf16 v10, v13, v6, v10
    v_dot2_f32_bf16 v11, v13, v13, v11
    v_dot2_f32_bf16 v10, v14, v6, v10
    v_dot2_f32_bf16 v11, v14, v14, v11
    v_dot2_f32_bf16 v10, v15, v6, v10
    v_dot2_f32_bf16 v11, v15, v15, v11
    s_nop 1
    v_add_f32_dpp v10, v10, v10 quad_perm:[1,0,3,2] row_mask:0xf bank_mask:0xf
    s_nop 1
    v_add_f32_dpp v10, v10, v10 quad_perm:[2,3,0,1] row_mask:0xf bank_mask:0xf
    s_nop 1
    v_add_f32_dpp v10, v10, v10 row_half_mirror row_mask:0xf bank_mask:0xf
    s_nop 1
    v_add_f32_dpp v10, v10, v10 row_mirror row_mask:0xf bank_mask:0xf
    s_nop 1
    v_readlane_b32 s82, v10, 0
    v_readlane_b32 s83, v10, 16
    v_readlane_b32 s84, v10, 32
    v_readlane_b32 s85, v10, 48
    s_nop 1
    v_mov_b32 v10, s82
    v_add_f32 v10, s83, v10
    v_add_f32 v10, s84, v10
    v_add_f32 v10, s85, v10
    s_nop 1
    v_add_f32_dpp v11, v11, v11 quad_perm:[1,0,3,2] row_mask:0xf bank_mask:0xf
    s_nop 1
    v_add_f32_dpp v11, v11, v11 quad_perm:[2,3,0,1] row_mask:0xf bank_mask:0xf
    s_nop 1
    v_add_f32_dpp v11, v11, v11 row_half_mirror row_mask:0xf bank_mask:0xf
    s_nop 1
    v_add_f32_dpp v11, v11, v11 row_mirror row_mask:0xf bank_mask:0xf
    s_nop 1
    v_readlane_b32 s82, v11, 0
    v_readlane_b32 s83, v11, 16
    v_readlane_b32 s84, v11, 32
    v_readlane_b32 s85, v11, 48
    s_nop 1
    v_mov_b32 v11, s82
    v_add_f32 v11, s83, v11
    v_add_f32 v11, s84, v11
    v_add_f32 v11, s85, v11
    v_mul_f32 v10, 0x3b000000, v10
    v_mul_f32 v11, 0x3b000000, v11
    v_fma_f32 v11, -v10, v10, v11
    v_max_f32 v11, 0, v11
    v_add_f32 v11, 0x3727c5ac, v11
    v_rsq_f32 v11, v11
    s_nop 0
    s_waitcnt vmcnt(16)
    v_lshlrev_b32 v32, 16, v12
    v_sub_f32 v32, v32, v10
    v_mul_f32 v32, v32, v11
    v_add_f32 v24, 1.0, v24
    v_fma_f32 v32, v32, v24, v16
    v_and_b32 v33, 0xffff0000, v12
    v_sub_f32 v33, v33, v10
    v_mul_f32 v33, v33, v11
    v_add_f32 v25, 1.0, v25
    v_fma_f32 v33, v33, v25, v17
    v_lshlrev_b32 v34, 16, v13
    v_sub_f32 v34, v34, v10
    v_mul_f32 v34, v34, v11
    v_add_f32 v26, 1.0, v26
    v_fma_f32 v34, v34, v26, v18
    v_and_b32 v35, 0xffff0000, v13
    v_sub_f32 v35, v35, v10
    v_mul_f32 v35, v35, v11
    v_add_f32 v27, 1.0, v27
    v_fma_f32 v35, v35, v27, v19
    v_lshlrev_b32 v36, 16, v14
    v_sub_f32 v36, v36, v10
    v_mul_f32 v36, v36, v11
    v_add_f32 v28, 1.0, v28
    v_fma_f32 v36, v36, v28, v20
    v_and_b32 v37, 0xffff0000, v14
    v_sub_f32 v37, v37, v10
    v_mul_f32 v37, v37, v11
    v_add_f32 v29, 1.0, v29
    v_fma_f32 v37, v37, v29, v21
    v_lshlrev_b32 v38, 16, v15
    v_sub_f32 v38, v38, v10
    v_mul_f32 v38, v38, v11
    v_add_f32 v30, 1.0, v30
    v_fma_f32 v38, v38, v30, v22
    v_and_b32 v39, 0xffff0000, v15
    v_sub_f32 v39, v39, v10
    v_mul_f32 v39, v39, v11
    v_add_f32 v31, 1.0, v31
    v_fma_f32 v39, v39, v31, v23
    v_cvt_pk_bf16_f32 v12, v32, v33
    v_cvt_pk_bf16_f32 v13, v34, v35
    v_cvt_pk_bf16_f32 v14, v36, v37
    v_cvt_pk_bf16_f32 v15, v38, v39
    buffer_store_dwordx4 v[12:15], v4, s[76:79], s80 offen
    v_and_b32 v189, 31, v188
    v_lshrrev_b32 v190, 5, v188
    v_lshrrev_b32 v191, 1, v189
    v_and_b32 v191, 7, v191
    s_mul_i32 s37, s35, 128
    v_add_u32 v189, s37, v189
    v_lshlrev_b32 v189, 7, v189
    s_mul_i32 s37, s33, 8
    v_add_u32 v190, s37, v190
    v_add_u32 v192, 0, v190
    v_xor_b32 v192, v192, v191
    v_lshl_add_u32 v193, v192, 4, v189
    v_add_u32 v192, 2, v190
    v_xor_b32 v192, v192, v191
    v_lshl_add_u32 v194, v192, 4, v189
    v_add_u32 v192, 4, v190
    v_xor_b32 v192, v192, v191
    v_lshl_add_u32 v195, v192, 4, v189
    v_add_u32 v192, 6, v190
    v_xor_b32 v192, v192, v191
    v_lshl_add_u32 v196, v192, 4, v189
    v_bfe_u32 v189, v188, 2, 2
    v_lshrrev_b32 v190, 5, v188
    v_lshlrev_b32 v190, 3, v190
    v_add_u32 v190, v190, v189
    s_mul_i32 s37, s33, 64
    v_add_u32 v190, s37, v190
    v_lshlrev_b32 v190, 9, v190
    v_and_b32 v191, 3, v188
    v_lshlrev_b32 v191, 3, v191
    v_add_u32 v190, v190, v191
    v_bfe_u32 v191, v188, 4, 1
    v_lshlrev_b32 v191, 5, v191
    v_add_u32 v190, v190, v191
    s_mul_i32 s37, s36, 2
    s_add_u32 s38, s37, 0
    v_xor_b32 v191, s38, v189
    v_lshl_add_u32 v191, v191, 6, v190
    v_add_u32 v197, 0x8000, v191
    s_add_u32 s38, s37, 1
    v_xor_b32 v191, s38, v189
    v_lshl_add_u32 v191, v191, 6, v190
    v_add_u32 v198, 0x8000, v191
    s_waitcnt vmcnt(9)
    s_barrier
    ds_read_b128 v[132:135], v193 offset:0
    ds_read_b128 v[136:139], v193 offset:4096
    ds_read_b128 v[140:143], v193 offset:8192
    ds_read_b128 v[144:147], v193 offset:12288
    ds_read_b64_tr_b16 v[148:149], v197 offset:0
    ds_read_b64_tr_b16 v[150:151], v197 offset:2048
    ds_read_b64_tr_b16 v[152:153], v198 offset:0
    ds_read_b64_tr_b16 v[154:155], v198 offset:2048
    ds_read_b128 v[156:159], v194 offset:0
    ds_read_b128 v[160:163], v194 offset:4096
    ds_read_b128 v[164:167], v194 offset:8192
    ds_read_b128 v[168:171], v194 offset:12288
    ds_read_b64_tr_b16 v[172:173], v197 offset:8192
    ds_read_b64_tr_b16 v[174:175], v197 offset:10240
    ds_read_b64_tr_b16 v[176:177], v198 offset:8192
    ds_read_b64_tr_b16 v[178:179], v198 offset:10240
    s_waitcnt lgkmcnt(8)
    v_mfma_f32_32x32x16_bf16 v[4:19], v[148:151], v[132:135], 0
    v_mfma_f32_32x32x16_bf16 v[20:35], v[152:155], v[132:135], 0
    v_mfma_f32_32x32x16_bf16 v[36:51], v[148:151], v[136:139], 0
    v_mfma_f32_32x32x16_bf16 v[52:67], v[152:155], v[136:139], 0
    v_mfma_f32_32x32x16_bf16 v[68:83], v[148:151], v[140:143], 0
    v_mfma_f32_32x32x16_bf16 v[84:99], v[152:155], v[140:143], 0
    v_mfma_f32_32x32x16_bf16 v[100:115], v[148:151], v[144:147], 0
    v_mfma_f32_32x32x16_bf16 v[116:131], v[152:155], v[144:147], 0
    ds_read_b128 v[132:135], v195 offset:0
    ds_read_b128 v[136:139], v195 offset:4096
    ds_read_b128 v[140:143], v195 offset:8192
    ds_read_b128 v[144:147], v195 offset:12288
    ds_read_b64_tr_b16 v[148:149], v197 offset:16384
    ds_read_b64_tr_b16 v[150:151], v197 offset:18432
    ds_read_b64_tr_b16 v[152:153], v198 offset:16384
    ds_read_b64_tr_b16 v[154:155], v198 offset:18432
    s_waitcnt lgkmcnt(8)
    v_mfma_f32_32x32x16_bf16 v[4:19], v[172:175], v[156:159], v[4:19]
    v_mfma_f32_32x32x16_bf16 v[20:35], v[176:179], v[156:159], v[20:35]
    v_mfma_f32_32x32x16_bf16 v[36:51], v[172:175], v[160:163], v[36:51]
    v_mfma_f32_32x32x16_bf16 v[52:67], v[176:179], v[160:163], v[52:67]
    v_mfma_f32_32x32x16_bf16 v[68:83], v[172:175], v[164:167], v[68:83]
    v_mfma_f32_32x32x16_bf16 v[84:99], v[176:179], v[164:167], v[84:99]
    v_mfma_f32_32x32x16_bf16 v[100:115], v[172:175], v[168:171], v[100:115]
    v_mfma_f32_32x32x16_bf16 v[116:131], v[176:179], v[168:171], v[116:131]
    ds_read_b128 v[156:159], v196 offset:0
    ds_read_b128 v[160:163], v196 offset:4096
    ds_read_b128 v[164:167], v196 offset:8192
    ds_read_b128 v[168:171], v196 offset:12288
    ds_read_b64_tr_b16 v[172:173], v197 offset:24576
    ds_read_b64_tr_b16 v[174:175], v197 offset:26624
    ds_read_b64_tr_b16 v[176:177], v198 offset:24576
    ds_read_b64_tr_b16 v[178:179], v198 offset:26624
    s_waitcnt lgkmcnt(8)
    v_mfma_f32_32x32x16_bf16 v[4:19], v[148:151], v[132:135], v[4:19]
    v_mfma_f32_32x32x16_bf16 v[20:35], v[152:155], v[132:135], v[20:35]
    v_mfma_f32_32x32x16_bf16 v[36:51], v[148:151], v[136:139], v[36:51]
    v_mfma_f32_32x32x16_bf16 v[52:67], v[152:155], v[136:139], v[52:67]
    v_mfma_f32_32x32x16_bf16 v[68:83], v[148:151], v[140:143], v[68:83]
    v_mfma_f32_32x32x16_bf16 v[84:99], v[152:155], v[140:143], v[84:99]
    v_mfma_f32_32x32x16_bf16 v[100:115], v[148:151], v[144:147], v[100:115]
    v_mfma_f32_32x32x16_bf16 v[116:131], v[152:155], v[144:147], v[116:131]
    s_waitcnt lgkmcnt(0)
    v_mfma_f32_32x32x16_bf16 v[4:19], v[172:175], v[156:159], v[4:19]
    v_mfma_f32_32x32x16_bf16 v[20:35], v[176:179], v[156:159], v[20:35]
    v_mfma_f32_32x32x16_bf16 v[36:51], v[172:175], v[160:163], v[36:51]
    v_mfma_f32_32x32x16_bf16 v[52:67], v[176:179], v[160:163], v[52:67]
    s_add_u32 s45, s45, 0x10000
    s_cmp_ge_u32 s45, 0x20000
    s_cselect_b32 s46, 0xffff0000, s48
    s_cselect_b32 s45, 0, s45
    v_add_u32 v193, s46, v193
    v_add_u32 v194, s46, v194
    v_add_u32 v195, s46, v195
    v_add_u32 v196, s46, v196
    v_add_u32 v197, s46, v197
    v_add_u32 v198, s46, v198
    s_waitcnt vmcnt(1)
    s_barrier
    ds_read_b128 v[132:135], v193 offset:0
    ds_read_b128 v[136:139], v193 offset:4096
    ds_read_b128 v[140:143], v193 offset:8192
    ds_read_b128 v[144:147], v193 offset:12288
    ds_read_b64_tr_b16 v[148:149], v197 offset:0
    ds_read_b64_tr_b16 v[150:151], v197 offset:2048
    ds_read_b64_tr_b16 v[152:153], v198 offset:0
    ds_read_b64_tr_b16 v[154:155], v198 offset:2048
    v_mfma_f32_32x32x16_bf16 v[68:83], v[172:175], v[164:167], v[68:83]
    v_mfma_f32_32x32x16_bf16 v[84:99], v[176:179], v[164:167], v[84:99]
    v_mfma_f32_32x32x16_bf16 v[100:115], v[172:175], v[168:171], v[100:115]
    v_mfma_f32_32x32x16_bf16 v[116:131], v[176:179], v[168:171], v[116:131]
    s_mov_b32 s47, 5
kvprep_kernel_k_loop:
    ds_read_b128 v[156:159], v194 offset:0
    ds_read_b128 v[160:163], v194 offset:4096
    ds_read_b128 v[164:167], v194 offset:8192
    ds_read_b128 v[168:171], v194 offset:12288
    ds_read_b64_tr_b16 v[172:173], v197 offset:8192
    ds_read_b64_tr_b16 v[174:175], v197 offset:10240
    ds_read_b64_tr_b16 v[176:177], v198 offset:8192
    ds_read_b64_tr_b16 v[178:179], v198 offset:10240
    s_waitcnt lgkmcnt(8)
    v_mfma_f32_32x32x16_bf16 v[4:19], v[148:151], v[132:135], v[4:19]
    s_add_u32 m0, s44, 0x0
    s_nop 0
    buffer_load_dwordx4 v180, s[4:7], s29 offen lds
    v_mfma_f32_32x32x16_bf16 v[20:35], v[152:155], v[132:135], v[20:35]
    s_add_u32 m0, s44, 0x2000
    s_nop 0
    buffer_load_dwordx4 v181, s[4:7], s29 offen lds
    v_mfma_f32_32x32x16_bf16 v[36:51], v[148:151], v[136:139], v[36:51]
    s_add_u32 m0, s44, 0x4000
    s_nop 0
    buffer_load_dwordx4 v182, s[4:7], s29 offen lds
    v_mfma_f32_32x32x16_bf16 v[52:67], v[152:155], v[136:139], v[52:67]
    s_add_u32 m0, s44, 0x6000
    s_nop 0
    buffer_load_dwordx4 v183, s[4:7], s29 offen lds
    v_mfma_f32_32x32x16_bf16 v[68:83], v[148:151], v[140:143], v[68:83]
    s_add_u32 m0, s44, 0x8000
    s_nop 0
    buffer_load_dwordx4 v184, s[8:11], s30 offen lds
    v_mfma_f32_32x32x16_bf16 v[84:99], v[152:155], v[140:143], v[84:99]
    s_add_u32 m0, s44, 0xa000
    s_nop 0
    buffer_load_dwordx4 v185, s[8:11], s30 offen lds
    v_mfma_f32_32x32x16_bf16 v[100:115], v[148:151], v[144:147], v[100:115]
    s_add_u32 m0, s44, 0xc000
    s_nop 0
    buffer_load_dwordx4 v186, s[8:11], s30 offen lds
    v_mfma_f32_32x32x16_bf16 v[116:131], v[152:155], v[144:147], v[116:131]
    s_add_u32 m0, s44, 0xe000
    s_nop 0
    buffer_load_dwordx4 v187, s[8:11], s30 offen lds
    s_add_u32 s49, s49, 1
    s_cmp_ge_u32 s49, 8
    s_cselect_b32 s49, 0, s49
    s_mul_i32 s30, s49, 64
    s_add_u32 s30, s30, s43
    s_lshl_b32 s29, s30, 1
    s_mul_i32 s30, s30, 8192
    s_add_u32 s44, s44, 0x10000
    s_sub_u32 s46, s44, s31
    s_cmp_ge_u32 s46, 0x20000
    s_cselect_b32 s44, s31, s44
    ds_read_b128 v[132:135], v195 offset:0
    ds_read_b128 v[136:139], v195 offset:4096
    ds_read_b128 v[140:143], v195 offset:8192
    ds_read_b128 v[144:147], v195 offset:12288
    ds_read_b64_tr_b16 v[148:149], v197 offset:16384
    ds_read_b64_tr_b16 v[150:151], v197 offset:18432
    ds_read_b64_tr_b16 v[152:153], v198 offset:16384
    ds_read_b64_tr_b16 v[154:155], v198 offset:18432
    s_waitcnt lgkmcnt(8)
    v_mfma_f32_32x32x16_bf16 v[4:19], v[172:175], v[156:159], v[4:19]
    v_mfma_f32_32x32x16_bf16 v[20:35], v[176:179], v[156:159], v[20:35]
    v_mfma_f32_32x32x16_bf16 v[36:51], v[172:175], v[160:163], v[36:51]
    v_mfma_f32_32x32x16_bf16 v[52:67], v[176:179], v[160:163], v[52:67]
    v_mfma_f32_32x32x16_bf16 v[68:83], v[172:175], v[164:167], v[68:83]
    v_mfma_f32_32x32x16_bf16 v[84:99], v[176:179], v[164:167], v[84:99]
    v_mfma_f32_32x32x16_bf16 v[100:115], v[172:175], v[168:171], v[100:115]
    v_mfma_f32_32x32x16_bf16 v[116:131], v[176:179], v[168:171], v[116:131]
    ds_read_b128 v[156:159], v196 offset:0
    ds_read_b128 v[160:163], v196 offset:4096
    ds_read_b128 v[164:167], v196 offset:8192
    ds_read_b128 v[168:171], v196 offset:12288
    ds_read_b64_tr_b16 v[172:173], v197 offset:24576
    ds_read_b64_tr_b16 v[174:175], v197 offset:26624
    ds_read_b64_tr_b16 v[176:177], v198 offset:24576
    ds_read_b64_tr_b16 v[178:179], v198 offset:26624
    s_waitcnt lgkmcnt(8)
    v_mfma_f32_32x32x16_bf16 v[4:19], v[148:151], v[132:135], v[4:19]
    v_mfma_f32_32x32x16_bf16 v[20:35], v[152:155], v[132:135], v[20:35]
    v_mfma_f32_32x32x16_bf16 v[36:51], v[148:151], v[136:139], v[36:51]
    v_mfma_f32_32x32x16_bf16 v[52:67], v[152:155], v[136:139], v[52:67]
    v_mfma_f32_32x32x16_bf16 v[68:83], v[148:151], v[140:143], v[68:83]
    v_mfma_f32_32x32x16_bf16 v[84:99], v[152:155], v[140:143], v[84:99]
    v_mfma_f32_32x32x16_bf16 v[100:115], v[148:151], v[144:147], v[100:115]
    v_mfma_f32_32x32x16_bf16 v[116:131], v[152:155], v[144:147], v[116:131]
    s_waitcnt lgkmcnt(0)
    v_mfma_f32_32x32x16_bf16 v[4:19], v[172:175], v[156:159], v[4:19]
    v_mfma_f32_32x32x16_bf16 v[20:35], v[176:179], v[156:159], v[20:35]
    v_mfma_f32_32x32x16_bf16 v[36:51], v[172:175], v[160:163], v[36:51]
    v_mfma_f32_32x32x16_bf16 v[52:67], v[176:179], v[160:163], v[52:67]
    s_add_u32 s45, s45, 0x10000
    s_cmp_ge_u32 s45, 0x20000
    s_cselect_b32 s46, 0xffff0000, s48
    s_cselect_b32 s45, 0, s45
    v_add_u32 v193, s46, v193
    v_add_u32 v194, s46, v194
    v_add_u32 v195, s46, v195
    v_add_u32 v196, s46, v196
    v_add_u32 v197, s46, v197
    v_add_u32 v198, s46, v198
    s_waitcnt vmcnt(0)
    s_barrier
    ds_read_b128 v[132:135], v193 offset:0
    ds_read_b128 v[136:139], v193 offset:4096
    ds_read_b128 v[140:143], v193 offset:8192
    ds_read_b128 v[144:147], v193 offset:12288
    ds_read_b64_tr_b16 v[148:149], v197 offset:0
    ds_read_b64_tr_b16 v[150:151], v197 offset:2048
    ds_read_b64_tr_b16 v[152:153], v198 offset:0
    ds_read_b64_tr_b16 v[154:155], v198 offset:2048
    v_mfma_f32_32x32x16_bf16 v[68:83], v[172:175], v[164:167], v[68:83]
    v_mfma_f32_32x32x16_bf16 v[84:99], v[176:179], v[164:167], v[84:99]
    v_mfma_f32_32x32x16_bf16 v[100:115], v[172:175], v[168:171], v[100:115]
    v_mfma_f32_32x32x16_bf16 v[116:131], v[176:179], v[168:171], v[116:131]
    s_sub_u32 s47, s47, 1
    s_cmp_lg_u32 s47, 0
    s_cbranch_scc1 kvprep_kernel_k_loop
    ds_read_b128 v[156:159], v194 offset:0
    ds_read_b128 v[160:163], v194 offset:4096
    ds_read_b128 v[164:167], v194 offset:8192
    ds_read_b128 v[168:171], v194 offset:12288
    ds_read_b64_tr_b16 v[172:173], v197 offset:8192
    ds_read_b64_tr_b16 v[174:175], v197 offset:10240
    ds_read_b64_tr_b16 v[176:177], v198 offset:8192
    ds_read_b64_tr_b16 v[178:179], v198 offset:10240
    s_waitcnt lgkmcnt(8)
    v_mfma_f32_32x32x16_bf16 v[4:19], v[148:151], v[132:135], v[4:19]
    s_add_u32 m0, s44, 0x0
    s_nop 0
    buffer_load_dwordx4 v180, s[4:7], s29 offen lds
    v_mfma_f32_32x32x16_bf16 v[20:35], v[152:155], v[132:135], v[20:35]
    s_add_u32 m0, s44, 0x2000
    s_nop 0
    buffer_load_dwordx4 v181, s[4:7], s29 offen lds
    v_mfma_f32_32x32x16_bf16 v[36:51], v[148:151], v[136:139], v[36:51]
    s_add_u32 m0, s44, 0x4000
    s_nop 0
    buffer_load_dwordx4 v182, s[4:7], s29 offen lds
    v_mfma_f32_32x32x16_bf16 v[52:67], v[152:155], v[136:139], v[52:67]
    s_add_u32 m0, s44, 0x6000
    s_nop 0
    buffer_load_dwordx4 v183, s[4:7], s29 offen lds
    v_mfma_f32_32x32x16_bf16 v[68:83], v[148:151], v[140:143], v[68:83]
    s_add_u32 m0, s44, 0x8000
    s_nop 0
    buffer_load_dwordx4 v184, s[8:11], s30 offen lds
    v_mfma_f32_32x32x16_bf16 v[84:99], v[152:155], v[140:143], v[84:99]
    s_add_u32 m0, s44, 0xa000
    s_nop 0
    buffer_load_dwordx4 v185, s[8:11], s30 offen lds
    v_mfma_f32_32x32x16_bf16 v[100:115], v[148:151], v[144:147], v[100:115]
    s_add_u32 m0, s44, 0xc000
    s_nop 0
    buffer_load_dwordx4 v186, s[8:11], s30 offen lds
    v_mfma_f32_32x32x16_bf16 v[116:131], v[152:155], v[144:147], v[116:131]
    s_add_u32 m0, s44, 0xe000
    s_nop 0
    buffer_load_dwordx4 v187, s[8:11], s30 offen lds
    s_add_u32 s49, s49, 1
    s_cmp_ge_u32 s49, 8
    s_cselect_b32 s49, 0, s49
    s_mul_i32 s30, s49, 64
    s_add_u32 s30, s30, s43
    s_lshl_b32 s29, s30, 1
    s_mul_i32 s30, s30, 8192
    s_add_u32 s44, s44, 0x10000
    s_sub_u32 s46, s44, s31
    s_cmp_ge_u32 s46, 0x20000
    s_cselect_b32 s44, s31, s44
    ds_read_b128 v[132:135], v195 offset:0
    ds_read_b128 v[136:139], v195 offset:4096
    ds_read_b128 v[140:143], v195 offset:8192
    ds_read_b128 v[144:147], v195 offset:12288
    ds_read_b64_tr_b16 v[148:149], v197 offset:16384
    ds_read_b64_tr_b16 v[150:151], v197 offset:18432
    ds_read_b64_tr_b16 v[152:153], v198 offset:16384
    ds_read_b64_tr_b16 v[154:155], v198 offset:18432
    s_waitcnt lgkmcnt(8)
    v_mfma_f32_32x32x16_bf16 v[4:19], v[172:175], v[156:159], v[4:19]
    buffer_load_dwordx4 v[204:207], v200, s[20:23], s26 offen
    v_mfma_f32_32x32x16_bf16 v[20:35], v[176:179], v[156:159], v[20:35]
    buffer_load_dwordx4 v[208:211], v200, s[20:23], s27 offen
    v_mfma_f32_32x32x16_bf16 v[36:51], v[172:175], v[160:163], v[36:51]
    v_mfma_f32_32x32x16_bf16 v[52:67], v[176:179], v[160:163], v[52:67]
    v_mfma_f32_32x32x16_bf16 v[68:83], v[172:175], v[164:167], v[68:83]
    v_mfma_f32_32x32x16_bf16 v[84:99], v[176:179], v[164:167], v[84:99]
    v_mfma_f32_32x32x16_bf16 v[100:115], v[172:175], v[168:171], v[100:115]
    v_mfma_f32_32x32x16_bf16 v[116:131], v[176:179], v[168:171], v[116:131]
    ds_read_b128 v[156:159], v196 offset:0
    ds_read_b128 v[160:163], v196 offset:4096
    ds_read_b128 v[164:167], v196 offset:8192
    ds_read_b128 v[168:171], v196 offset:12288
    ds_read_b64_tr_b16 v[172:173], v197 offset:24576
    ds_read_b64_tr_b16 v[174:175], v197 offset:26624
    ds_read_b64_tr_b16 v[176:177], v198 offset:24576
    ds_read_b64_tr_b16 v[178:179], v198 offset:26624
    s_waitcnt lgkmcnt(8)
    v_mfma_f32_32x32x16_bf16 v[4:19], v[148:151], v[132:135], v[4:19]
    v_mfma_f32_32x32x16_bf16 v[20:35], v[152:155], v[132:135], v[20:35]
    v_mfma_f32_32x32x16_bf16 v[36:51], v[148:151], v[136:139], v[36:51]
    v_mfma_f32_32x32x16_bf16 v[52:67], v[152:155], v[136:139], v[52:67]
    v_mfma_f32_32x32x16_bf16 v[68:83], v[148:151], v[140:143], v[68:83]
    v_mfma_f32_32x32x16_bf16 v[84:99], v[152:155], v[140:143], v[84:99]
    v_mfma_f32_32x32x16_bf16 v[100:115], v[148:151], v[144:147], v[100:115]
    v_mfma_f32_32x32x16_bf16 v[116:131], v[152:155], v[144:147], v[116:131]
    s_waitcnt lgkmcnt(0)
    v_mfma_f32_32x32x16_bf16 v[4:19], v[172:175], v[156:159], v[4:19]
    v_mfma_f32_32x32x16_bf16 v[20:35], v[176:179], v[156:159], v[20:35]
    v_mfma_f32_32x32x16_bf16 v[36:51], v[172:175], v[160:163], v[36:51]
    v_mfma_f32_32x32x16_bf16 v[52:67], v[176:179], v[160:163], v[52:67]
    s_add_u32 s45, s45, 0x10000
    s_cmp_ge_u32 s45, 0x20000
    s_cselect_b32 s46, 0xffff0000, s48
    s_cselect_b32 s45, 0, s45
    v_add_u32 v193, s46, v193
    v_add_u32 v194, s46, v194
    v_add_u32 v195, s46, v195
    v_add_u32 v196, s46, v196
    v_add_u32 v197, s46, v197
    v_add_u32 v198, s46, v198
    s_waitcnt vmcnt(2)
    s_barrier
    ds_read_b128 v[132:135], v193 offset:0
    ds_read_b128 v[136:139], v193 offset:4096
    ds_read_b128 v[140:143], v193 offset:8192
    ds_read_b128 v[144:147], v193 offset:12288
    ds_read_b64_tr_b16 v[148:149], v197 offset:0
    ds_read_b64_tr_b16 v[150:151], v197 offset:2048
    ds_read_b64_tr_b16 v[152:153], v198 offset:0
    ds_read_b64_tr_b16 v[154:155], v198 offset:2048
    v_mfma_f32_32x32x16_bf16 v[68:83], v[172:175], v[164:167], v[68:83]
    v_mfma_f32_32x32x16_bf16 v[84:99], v[176:179], v[164:167], v[84:99]
    v_mfma_f32_32x32x16_bf16 v[100:115], v[172:175], v[168:171], v[100:115]
    v_mfma_f32_32x32x16_bf16 v[116:131], v[176:179], v[168:171], v[116:131]
    s_mul_i32 s37, s35, 128
    s_add_u32 s37, s37, s40
    s_mul_i32 s38, s36, 64
    s_add_u32 s38, s38, s42
    s_lshr_b32 s39, s38, 7
    s_lshl_b32 s39, s39, 19
    s_and_b32 s38, s38, 127
    s_lshl_b32 s38, s38, 6
    s_add_u32 s39, s39, s38
    s_lshl_b32 s37, s37, 8
    s_add_u32 s39, s39, s37
    v_lshl_add_u32 v189, v188, 4, s39
    ds_read_b64_tr_b16 v[212:213], v197 offset:8192
    ds_read_b64_tr_b16 v[214:215], v197 offset:10240
    ds_read_b64_tr_b16 v[216:217], v198 offset:8192
    ds_read_b64_tr_b16 v[218:219], v198 offset:10240
    ds_read_b128 v[156:159], v194 offset:0
    s_waitcnt lgkmcnt(5)
    v_mfma_f32_32x32x16_bf16 v[4:19], v[148:151], v[132:135], v[4:19]
    v_mfma_f32_32x32x16_bf16 v[20:35], v[152:155], v[132:135], v[20:35]
    ds_read_b64_tr_b16 v[220:221], v197 offset:16384
    ds_read_b64_tr_b16 v[222:223], v197 offset:18432
    ds_read_b64_tr_b16 v[224:225], v198 offset:16384
    ds_read_b64_tr_b16 v[226:227], v198 offset:18432
    ds_read_b128 v[160:163], v195 offset:0
    s_waitcnt lgkmcnt(5)
    v_mfma_f32_32x32x16_bf16 v[4:19], v[212:215], v[156:159], v[4:19]
    v_mfma_f32_32x32x16_bf16 v[20:35], v[216:219], v[156:159], v[20:35]
    ds_read_b64_tr_b16 v[228:229], v197 offset:24576
    ds_read_b64_tr_b16 v[230:231], v197 offset:26624
    ds_read_b64_tr_b16 v[232:233], v198 offset:24576
    ds_read_b64_tr_b16 v[234:235], v198 offset:26624
    ds_read_b128 v[164:167], v196 offset:0
    s_waitcnt lgkmcnt(5)
    v_mfma_f32_32x32x16_bf16 v[4:19], v[220:223], v[160:163], v[4:19]
    v_mfma_f32_32x32x16_bf16 v[20:35], v[224:227], v[160:163], v[20:35]
    ds_read_b128 v[168:171], v194 offset:4096
    ds_read_b128 v[172:175], v195 offset:4096
    ds_read_b128 v[176:179], v196 offset:4096
    s_waitcnt lgkmcnt(3)
    v_mfma_f32_32x32x16_bf16 v[4:19], v[228:231], v[164:167], v[4:19]
    v_mfma_f32_32x32x16_bf16 v[20:35], v[232:235], v[164:167], v[20:35]
    ds_read_b128 v[156:159], v194 offset:8192
    ds_read_b128 v[160:163], v195 offset:8192
    ds_read_b128 v[164:167], v196 offset:8192
    v_mfma_f32_32x32x16_bf16 v[36:51], v[148:151], v[136:139], v[36:51]
    v_mfma_f32_32x32x16_bf16 v[52:67], v[152:155], v[136:139], v[52:67]
    s_waitcnt lgkmcnt(3)
    v_mfma_f32_32x32x16_bf16 v[36:51], v[212:215], v[168:171], v[36:51]
    v_cvt_pk_bf16_f32 v236, v4, v5
    v_cvt_pk_bf16_f32 v237, v6, v7
    v_cvt_pk_bf16_f32 v238, v8, v9
    v_cvt_pk_bf16_f32 v239, v10, v11
    s_mov_b32 s39, 0x0
    buffer_store_dwordx4 v[236:239], v189, s[16:19], s39 offen offset:0 sc1
    v_mfma_f32_32x32x16_bf16 v[52:67], v[216:219], v[168:171], v[52:67]
    v_cvt_pk_bf16_f32 v240, v12, v13
    v_cvt_pk_bf16_f32 v241, v14, v15
    v_cvt_pk_bf16_f32 v242, v16, v17
    v_cvt_pk_bf16_f32 v243, v18, v19
    s_mov_b32 s39, 0x0
    buffer_store_dwordx4 v[240:243], v189, s[16:19], s39 offen offset:1024 sc1
    v_mfma_f32_32x32x16_bf16 v[36:51], v[220:223], v[172:175], v[36:51]
    v_cvt_pk_bf16_f32 v244, v20, v21
    v_cvt_pk_bf16_f32 v245, v22, v23
    v_cvt_pk_bf16_f32 v246, v24, v25
    v_cvt_pk_bf16_f32 v247, v26, v27
    s_mov_b32 s39, 0x0
    buffer_store_dwordx4 v[244:247], v189, s[16:19], s39 offen offset:2048 sc1
    v_mfma_f32_32x32x16_bf16 v[52:67], v[224:227], v[172:175], v[52:67]
    v_cvt_pk_bf16_f32 v248, v28, v29
    v_cvt_pk_bf16_f32 v249, v30, v31
    v_cvt_pk_bf16_f32 v250, v32, v33
    v_cvt_pk_bf16_f32 v251, v34, v35
    s_mov_b32 s39, 0x0
    buffer_store_dwordx4 v[248:251], v189, s[16:19], s39 offen offset:3072 sc1
    v_mfma_f32_32x32x16_bf16 v[36:51], v[228:231], v[176:179], v[36:51]
    v_mfma_f32_32x32x16_bf16 v[52:67], v[232:235], v[176:179], v[52:67]
    ds_read_b128 v[168:171], v194 offset:12288
    ds_read_b128 v[172:175], v195 offset:12288
    ds_read_b128 v[176:179], v196 offset:12288
    v_mfma_f32_32x32x16_bf16 v[68:83], v[148:151], v[140:143], v[68:83]
    v_mfma_f32_32x32x16_bf16 v[84:99], v[152:155], v[140:143], v[84:99]
    s_waitcnt lgkmcnt(3)
    v_mfma_f32_32x32x16_bf16 v[68:83], v[212:215], v[156:159], v[68:83]
    v_cvt_pk_bf16_f32 v236, v36, v37
    v_cvt_pk_bf16_f32 v237, v38, v39
    v_cvt_pk_bf16_f32 v238, v40, v41
    v_cvt_pk_bf16_f32 v239, v42, v43
    s_mov_b32 s39, 0x2000
    buffer_store_dwordx4 v[236:239], v189, s[16:19], s39 offen offset:0 sc1
    v_mfma_f32_32x32x16_bf16 v[84:99], v[216:219], v[156:159], v[84:99]
    v_cvt_pk_bf16_f32 v240, v44, v45
    v_cvt_pk_bf16_f32 v241, v46, v47
    v_cvt_pk_bf16_f32 v242, v48, v49
    v_cvt_pk_bf16_f32 v243, v50, v51
    s_mov_b32 s39, 0x2000
    buffer_store_dwordx4 v[240:243], v189, s[16:19], s39 offen offset:1024 sc1
    v_mfma_f32_32x32x16_bf16 v[68:83], v[220:223], v[160:163], v[68:83]
    v_cvt_pk_bf16_f32 v244, v52, v53
    v_cvt_pk_bf16_f32 v245, v54, v55
    v_cvt_pk_bf16_f32 v246, v56, v57
    v_cvt_pk_bf16_f32 v247, v58, v59
    s_mov_b32 s39, 0x2000
    buffer_store_dwordx4 v[244:247], v189, s[16:19], s39 offen offset:2048 sc1
    v_mfma_f32_32x32x16_bf16 v[84:99], v[224:227], v[160:163], v[84:99]
    v_cvt_pk_bf16_f32 v248, v60, v61
    v_cvt_pk_bf16_f32 v249, v62, v63
    v_cvt_pk_bf16_f32 v250, v64, v65
    v_cvt_pk_bf16_f32 v251, v66, v67
    s_mov_b32 s39, 0x2000
    buffer_store_dwordx4 v[248:251], v189, s[16:19], s39 offen offset:3072 sc1
    v_mfma_f32_32x32x16_bf16 v[68:83], v[228:231], v[164:167], v[68:83]
    v_mfma_f32_32x32x16_bf16 v[84:99], v[232:235], v[164:167], v[84:99]
    v_mfma_f32_32x32x16_bf16 v[100:115], v[148:151], v[144:147], v[100:115]
    v_mfma_f32_32x32x16_bf16 v[116:131], v[152:155], v[144:147], v[116:131]
    s_waitcnt lgkmcnt(0)
    v_mfma_f32_32x32x16_bf16 v[100:115], v[212:215], v[168:171], v[100:115]
    v_cvt_pk_bf16_f32 v236, v68, v69
    v_cvt_pk_bf16_f32 v237, v70, v71
    v_cvt_pk_bf16_f32 v238, v72, v73
    v_cvt_pk_bf16_f32 v239, v74, v75
    s_mov_b32 s39, 0x4000
    buffer_store_dwordx4 v[236:239], v189, s[16:19], s39 offen offset:0 sc1
    v_mfma_f32_32x32x16_bf16 v[116:131], v[216:219], v[168:171], v[116:131]
    v_cvt_pk_bf16_f32 v240, v76, v77
    v_cvt_pk_bf16_f32 v241, v78, v79
    v_cvt_pk_bf16_f32 v242, v80, v81
    v_cvt_pk_bf16_f32 v243, v82, v83
    s_mov_b32 s39, 0x4000
    buffer_store_dwordx4 v[240:243], v189, s[16:19], s39 offen offset:1024 sc1
    v_mfma_f32_32x32x16_bf16 v[100:115], v[220:223], v[172:175], v[100:115]
    v_cvt_pk_bf16_f32 v244, v84, v85
    v_cvt_pk_bf16_f32 v245, v86, v87
    v_cvt_pk_bf16_f32 v246, v88, v89
    v_cvt_pk_bf16_f32 v247, v90, v91
    s_mov_b32 s39, 0x4000
    buffer_store_dwordx4 v[244:247], v189, s[16:19], s39 offen offset:2048 sc1
    v_mfma_f32_32x32x16_bf16 v[116:131], v[224:227], v[172:175], v[116:131]
    v_cvt_pk_bf16_f32 v248, v92, v93
    v_cvt_pk_bf16_f32 v249, v94, v95
    v_cvt_pk_bf16_f32 v250, v96, v97
    v_cvt_pk_bf16_f32 v251, v98, v99
    s_mov_b32 s39, 0x4000
    buffer_store_dwordx4 v[248:251], v189, s[16:19], s39 offen offset:3072 sc1
    v_mfma_f32_32x32x16_bf16 v[100:115], v[228:231], v[176:179], v[100:115]
    v_mfma_f32_32x32x16_bf16 v[116:131], v[232:235], v[176:179], v[116:131]
    s_nop 15
    s_nop 3
    v_cvt_pk_bf16_f32 v236, v100, v101
    v_cvt_pk_bf16_f32 v237, v102, v103
    v_cvt_pk_bf16_f32 v238, v104, v105
    v_cvt_pk_bf16_f32 v239, v106, v107
    s_mov_b32 s39, 0x6000
    buffer_store_dwordx4 v[236:239], v189, s[16:19], s39 offen offset:0 sc1
    v_cvt_pk_bf16_f32 v240, v108, v109
    v_cvt_pk_bf16_f32 v241, v110, v111
    v_cvt_pk_bf16_f32 v242, v112, v113
    v_cvt_pk_bf16_f32 v243, v114, v115
    s_mov_b32 s39, 0x6000
    buffer_store_dwordx4 v[240:243], v189, s[16:19], s39 offen offset:1024 sc1
    v_cvt_pk_bf16_f32 v244, v116, v117
    v_cvt_pk_bf16_f32 v245, v118, v119
    v_cvt_pk_bf16_f32 v246, v120, v121
    v_cvt_pk_bf16_f32 v247, v122, v123
    s_mov_b32 s39, 0x6000
    buffer_store_dwordx4 v[244:247], v189, s[16:19], s39 offen offset:2048 sc1
    v_cvt_pk_bf16_f32 v248, v124, v125
    v_cvt_pk_bf16_f32 v249, v126, v127
    v_cvt_pk_bf16_f32 v250, v128, v129
    v_cvt_pk_bf16_f32 v251, v130, v131
    s_mov_b32 s39, 0x6000
    buffer_store_dwordx4 v[248:251], v189, s[16:19], s39 offen offset:3072 sc1
    s_waitcnt vmcnt(0)
    s_endpgm
kvprep_kernel_v:
    s_sub_u32 s41, s41, 16
    s_lshl_b32 s41, s41, 8
    s_mov_b32 s42, s41
    s_mov_b32 s8, s48
    s_mov_b32 s9, s49
    s_mov_b32 s10, 0x400000
    s_mov_b32 s11, 0x00020000
    s_add_u32 s16, s50, 0x2400000
    s_addc_u32 s17, s51, 0
    s_mov_b32 s18, 0x1000000
    s_mov_b32 s19, 0x00020000
    v_lshrrev_b32 v1, 6, v0
    v_and_b32 v188, 63, v0
    s_nop 0
    v_readfirstlane_b32 s28, v1
    s_lshl_b32 s31, s28, 10
    s_lshr_b32 s33, s28, 3
    s_and_b32 s34, s28, 7
    s_and_b32 s35, s34, 1
    s_lshr_b32 s36, s34, 1
    v_lshrrev_b32 v189, 3, v188
    s_mul_i32 s37, s28, 8
    v_add_u32 v189, s37, v189
    v_and_b32 v190, 7, v188
    v_lshrrev_b32 v191, 1, v189
    v_and_b32 v191, 7, v191
    v_xor_b32 v190, v190, v191
    v_lshlrev_b32 v190, 4, v190
    v_add_u32 v189, s40, v189
    s_mov_b32 s37, 1024
    v_mul_lo_u32 v189, v189, s37
    v_add_u32 v180, v189, v190
    v_add_u32 v181, 0x10000, v180
    v_add_u32 v182, 0x20000, v180
    v_add_u32 v183, 0x30000, v180
    v_lshrrev_b32 v189, 5, v188
    s_mul_i32 s37, s28, 2
    v_add_u32 v189, s37, v189
    v_and_b32 v190, 31, v188
    v_and_b32 v191, 3, v189
    v_lshlrev_b32 v191, 2, v191
    v_xor_b32 v190, v190, v191
    v_lshlrev_b32 v190, 4, v190
    s_mov_b32 s37, 8192
    v_mul_lo_u32 v189, v189, s37
    s_lshl_b32 s37, s41, 1
    v_add3_u32 v184, v189, v190, s37
    v_add_u32 v185, 0x20000, v184
    v_add_u32 v186, 0x40000, v184
    v_add_u32 v187, 0x60000, v184
    s_mov_b32 s43, 0
    s_lshr_b32 s49, s2, 3
    s_and_b32 s49, s49, 7
    s_mul_i32 s30, s49, 64
    s_add_u32 s30, s30, s43
    s_lshl_b32 s29, s30, 1
    s_mul_i32 s30, s30, 8192
    s_load_dwordx2 s[52:53], s[0:1], 0
    s_load_dwordx2 s[58:59], s[0:1], 112
    v_and_b32 v1, 63, v0
    v_lshlrev_b32 v2, 5, v1
    v_lshlrev_b32 v4, 4, v0
    s_lshl_b32 s80, s2, 13
    s_movk_i32 s81, 2048
    s_waitcnt lgkmcnt(0)
    s_mov_b32 s60, s52
    s_mov_b32 s61, s53
    s_mov_b32 s62, 0x200000
    s_mov_b32 s63, 0x00020000
    s_mov_b32 s72, s58
    s_mov_b32 s73, s59
    s_mov_b32 s74, 0x1000
    s_mov_b32 s75, 0x00020000
    s_add_u32 s76, s58, 0x100000
    s_addc_u32 s77, s59, 0
    s_mov_b32 s78, 0x200000
    s_mov_b32 s79, 0x00020000
    buffer_load_dwordx4 v[12:15], v4, s[60:63], s80 offen
    buffer_load_dwordx4 v[16:19], v2, s[72:75], 0 offen offset:0
    buffer_load_dwordx4 v[24:27], v2, s[72:75], s81 offen offset:0
    buffer_load_dwordx4 v[20:23], v2, s[72:75], 0 offen offset:16
    buffer_load_dwordx4 v[28:31], v2, s[72:75], s81 offen offset:16
    s_add_u32 s44, s31, 0x0
    s_add_u32 m0, s44, 0x0
    s_nop 0
    buffer_load_dwordx4 v180, s[4:7], s29 offen lds
    s_add_u32 m0, s44, 0x2000
    s_nop 0
    buffer_load_dwordx4 v181, s[4:7], s29 offen lds
    s_add_u32 m0, s44, 0x4000
    s_nop 0
    buffer_load_dwordx4 v182, s[4:7], s29 offen lds
    s_add_u32 m0, s44, 0x6000
    s_nop 0
    buffer_load_dwordx4 v183, s[4:7], s29 offen lds
    s_add_u32 m0, s44, 0x8000
    s_nop 0
    buffer_load_dwordx4 v184, s[8:11], s30 offen lds
    s_add_u32 m0, s44, 0xa000
    s_nop 0
    buffer_load_dwordx4 v185, s[8:11], s30 offen lds
    s_add_u32 m0, s44, 0xc000
    s_nop 0
    buffer_load_dwordx4 v186, s[8:11], s30 offen lds
    s_add_u32 m0, s44, 0xe000
    s_nop 0
    buffer_load_dwordx4 v187, s[8:11], s30 offen lds
    s_add_u32 s49, s49, 1
    s_cmp_ge_u32 s49, 8
    s_cselect_b32 s49, 0, s49
    s_mul_i32 s30, s49, 64
    s_add_u32 s30, s30, s43
    s_lshl_b32 s29, s30, 1
    s_mul_i32 s30, s30, 8192
    s_add_u32 s44, s31, 0x10000
    s_add_u32 m0, s44, 0x0
    s_nop 0
    buffer_load_dwordx4 v180, s[4:7], s29 offen lds
    s_add_u32 m0, s44, 0x2000
    s_nop 0
    buffer_load_dwordx4 v181, s[4:7], s29 offen lds
    s_add_u32 m0, s44, 0x4000
    s_nop 0
    buffer_load_dwordx4 v182, s[4:7], s29 offen lds
    s_add_u32 m0, s44, 0x6000
    s_nop 0
    buffer_load_dwordx4 v183, s[4:7], s29 offen lds
    s_add_u32 m0, s44, 0x8000
    s_nop 0
    buffer_load_dwordx4 v184, s[8:11], s30 offen lds
    s_add_u32 m0, s44, 0xa000
    s_nop 0
    buffer_load_dwordx4 v185, s[8:11], s30 offen lds
    s_add_u32 m0, s44, 0xc000
    s_nop 0
    buffer_load_dwordx4 v186, s[8:11], s30 offen lds
    s_add_u32 m0, s44, 0xe000
    s_nop 0
    buffer_load_dwordx4 v187, s[8:11], s30 offen lds
    s_add_u32 s49, s49, 1
    s_cmp_ge_u32 s49, 8
    s_cselect_b32 s49, 0, s49
    s_mul_i32 s30, s49, 64
    s_add_u32 s30, s30, s43
    s_lshl_b32 s29, s30, 1
    s_mul_i32 s30, s30, 8192
    s_add_u32 s44, s31, 0x0
    s_mov_b32 s45, 0x0
    s_mov_b32 s48, 0x10000
    s_waitcnt vmcnt(20)
    v_mov_b32 v10, 0
    v_mov_b32 v11, 0
    v_mov_b32 v6, 0x3f803f80
    v_dot2_f32_bf16 v10, v12, v6, v10
    v_dot2_f32_bf16 v11, v12, v12, v11
    v_dot2_f32_bf16 v10, v13, v6, v10
    v_dot2_f32_bf16 v11, v13, v13, v11
    v_dot2_f32_bf16 v10, v14, v6, v10
    v_dot2_f32_bf16 v11, v14, v14, v11
    v_dot2_f32_bf16 v10, v15, v6, v10
    v_dot2_f32_bf16 v11, v15, v15, v11
    s_nop 1
    v_add_f32_dpp v10, v10, v10 quad_perm:[1,0,3,2] row_mask:0xf bank_mask:0xf
    s_nop 1
    v_add_f32_dpp v10, v10, v10 quad_perm:[2,3,0,1] row_mask:0xf bank_mask:0xf
    s_nop 1
    v_add_f32_dpp v10, v10, v10 row_half_mirror row_mask:0xf bank_mask:0xf
    s_nop 1
    v_add_f32_dpp v10, v10, v10 row_mirror row_mask:0xf bank_mask:0xf
    s_nop 1
    v_readlane_b32 s82, v10, 0
    v_readlane_b32 s83, v10, 16
    v_readlane_b32 s84, v10, 32
    v_readlane_b32 s85, v10, 48
    s_nop 1
    v_mov_b32 v10, s82
    v_add_f32 v10, s83, v10
    v_add_f32 v10, s84, v10
    v_add_f32 v10, s85, v10
    s_nop 1
    v_add_f32_dpp v11, v11, v11 quad_perm:[1,0,3,2] row_mask:0xf bank_mask:0xf
    s_nop 1
    v_add_f32_dpp v11, v11, v11 quad_perm:[2,3,0,1] row_mask:0xf bank_mask:0xf
    s_nop 1
    v_add_f32_dpp v11, v11, v11 row_half_mirror row_mask:0xf bank_mask:0xf
    s_nop 1
    v_add_f32_dpp v11, v11, v11 row_mirror row_mask:0xf bank_mask:0xf
    s_nop 1
    v_readlane_b32 s82, v11, 0
    v_readlane_b32 s83, v11, 16
    v_readlane_b32 s84, v11, 32
    v_readlane_b32 s85, v11, 48
    s_nop 1
    v_mov_b32 v11, s82
    v_add_f32 v11, s83, v11
    v_add_f32 v11, s84, v11
    v_add_f32 v11, s85, v11
    v_mul_f32 v10, 0x3b000000, v10
    v_mul_f32 v11, 0x3b000000, v11
    v_fma_f32 v11, -v10, v10, v11
    v_max_f32 v11, 0, v11
    v_add_f32 v11, 0x3727c5ac, v11
    v_rsq_f32 v11, v11
    s_nop 0
    s_waitcnt vmcnt(16)
    v_lshlrev_b32 v32, 16, v12
    v_sub_f32 v32, v32, v10
    v_mul_f32 v32, v32, v11
    v_add_f32 v24, 1.0, v24
    v_fma_f32 v32, v32, v24, v16
    v_and_b32 v33, 0xffff0000, v12
    v_sub_f32 v33, v33, v10
    v_mul_f32 v33, v33, v11
    v_add_f32 v25, 1.0, v25
    v_fma_f32 v33, v33, v25, v17
    v_lshlrev_b32 v34, 16, v13
    v_sub_f32 v34, v34, v10
    v_mul_f32 v34, v34, v11
    v_add_f32 v26, 1.0, v26
    v_fma_f32 v34, v34, v26, v18
    v_and_b32 v35, 0xffff0000, v13
    v_sub_f32 v35, v35, v10
    v_mul_f32 v35, v35, v11
    v_add_f32 v27, 1.0, v27
    v_fma_f32 v35, v35, v27, v19
    v_lshlrev_b32 v36, 16, v14
    v_sub_f32 v36, v36, v10
    v_mul_f32 v36, v36, v11
    v_add_f32 v28, 1.0, v28
    v_fma_f32 v36, v36, v28, v20
    v_and_b32 v37, 0xffff0000, v14
    v_sub_f32 v37, v37, v10
    v_mul_f32 v37, v37, v11
    v_add_f32 v29, 1.0, v29
    v_fma_f32 v37, v37, v29, v21
    v_lshlrev_b32 v38, 16, v15
    v_sub_f32 v38, v38, v10
    v_mul_f32 v38, v38, v11
    v_add_f32 v30, 1.0, v30
    v_fma_f32 v38, v38, v30, v22
    v_and_b32 v39, 0xffff0000, v15
    v_sub_f32 v39, v39, v10
    v_mul_f32 v39, v39, v11
    v_add_f32 v31, 1.0, v31
    v_fma_f32 v39, v39, v31, v23
    v_cvt_pk_bf16_f32 v12, v32, v33
    v_cvt_pk_bf16_f32 v13, v34, v35
    v_cvt_pk_bf16_f32 v14, v36, v37
    v_cvt_pk_bf16_f32 v15, v38, v39
    buffer_store_dwordx4 v[12:15], v4, s[76:79], s80 offen
    v_and_b32 v189, 31, v188
    v_lshrrev_b32 v190, 5, v188
    v_lshrrev_b32 v191, 1, v189
    v_and_b32 v191, 7, v191
    s_mul_i32 s37, s35, 128
    v_add_u32 v189, s37, v189
    v_lshlrev_b32 v189, 7, v189
    s_mul_i32 s37, s33, 8
    v_add_u32 v190, s37, v190
    v_add_u32 v192, 0, v190
    v_xor_b32 v192, v192, v191
    v_lshl_add_u32 v193, v192, 4, v189
    v_add_u32 v192, 2, v190
    v_xor_b32 v192, v192, v191
    v_lshl_add_u32 v194, v192, 4, v189
    v_add_u32 v192, 4, v190
    v_xor_b32 v192, v192, v191
    v_lshl_add_u32 v195, v192, 4, v189
    v_add_u32 v192, 6, v190
    v_xor_b32 v192, v192, v191
    v_lshl_add_u32 v196, v192, 4, v189
    v_bfe_u32 v189, v188, 2, 2
    v_lshrrev_b32 v190, 5, v188
    v_lshlrev_b32 v190, 3, v190
    v_add_u32 v190, v190, v189
    s_mul_i32 s37, s33, 64
    v_add_u32 v190, s37, v190
    v_lshlrev_b32 v190, 9, v190
    v_and_b32 v191, 3, v188
    v_lshlrev_b32 v191, 3, v191
    v_add_u32 v190, v190, v191
    v_bfe_u32 v191, v188, 4, 1
    v_lshlrev_b32 v191, 5, v191
    v_add_u32 v190, v190, v191
    s_mul_i32 s37, s36, 2
    s_add_u32 s38, s37, 0
    v_xor_b32 v191, s38, v189
    v_lshl_add_u32 v191, v191, 6, v190
    v_add_u32 v197, 0x8000, v191
    s_add_u32 s38, s37, 1
    v_xor_b32 v191, s38, v189
    v_lshl_add_u32 v191, v191, 6, v190
    v_add_u32 v198, 0x8000, v191
    s_waitcnt vmcnt(9)
    s_barrier
    ds_read_b128 v[132:135], v193 offset:0
    ds_read_b128 v[136:139], v193 offset:4096
    ds_read_b128 v[140:143], v193 offset:8192
    ds_read_b128 v[144:147], v193 offset:12288
    ds_read_b64_tr_b16 v[148:149], v197 offset:0
    ds_read_b64_tr_b16 v[150:151], v197 offset:2048
    ds_read_b64_tr_b16 v[152:153], v198 offset:0
    ds_read_b64_tr_b16 v[154:155], v198 offset:2048
    ds_read_b128 v[156:159], v194 offset:0
    ds_read_b128 v[160:163], v194 offset:4096
    ds_read_b128 v[164:167], v194 offset:8192
    ds_read_b128 v[168:171], v194 offset:12288
    ds_read_b64_tr_b16 v[172:173], v197 offset:8192
    ds_read_b64_tr_b16 v[174:175], v197 offset:10240
    ds_read_b64_tr_b16 v[176:177], v198 offset:8192
    ds_read_b64_tr_b16 v[178:179], v198 offset:10240
    s_waitcnt lgkmcnt(8)
    v_mfma_f32_32x32x16_bf16 v[4:19], v[132:135], v[148:151], 0
    v_mfma_f32_32x32x16_bf16 v[20:35], v[132:135], v[152:155], 0
    v_mfma_f32_32x32x16_bf16 v[36:51], v[136:139], v[148:151], 0
    v_mfma_f32_32x32x16_bf16 v[52:67], v[136:139], v[152:155], 0
    v_mfma_f32_32x32x16_bf16 v[68:83], v[140:143], v[148:151], 0
    v_mfma_f32_32x32x16_bf16 v[84:99], v[140:143], v[152:155], 0
    v_mfma_f32_32x32x16_bf16 v[100:115], v[144:147], v[148:151], 0
    v_mfma_f32_32x32x16_bf16 v[116:131], v[144:147], v[152:155], 0
    ds_read_b128 v[132:135], v195 offset:0
    ds_read_b128 v[136:139], v195 offset:4096
    ds_read_b128 v[140:143], v195 offset:8192
    ds_read_b128 v[144:147], v195 offset:12288
    ds_read_b64_tr_b16 v[148:149], v197 offset:16384
    ds_read_b64_tr_b16 v[150:151], v197 offset:18432
    ds_read_b64_tr_b16 v[152:153], v198 offset:16384
    ds_read_b64_tr_b16 v[154:155], v198 offset:18432
    s_waitcnt lgkmcnt(8)
    v_mfma_f32_32x32x16_bf16 v[4:19], v[156:159], v[172:175], v[4:19]
    v_mfma_f32_32x32x16_bf16 v[20:35], v[156:159], v[176:179], v[20:35]
    v_mfma_f32_32x32x16_bf16 v[36:51], v[160:163], v[172:175], v[36:51]
    v_mfma_f32_32x32x16_bf16 v[52:67], v[160:163], v[176:179], v[52:67]
    v_mfma_f32_32x32x16_bf16 v[68:83], v[164:167], v[172:175], v[68:83]
    v_mfma_f32_32x32x16_bf16 v[84:99], v[164:167], v[176:179], v[84:99]
    v_mfma_f32_32x32x16_bf16 v[100:115], v[168:171], v[172:175], v[100:115]
    v_mfma_f32_32x32x16_bf16 v[116:131], v[168:171], v[176:179], v[116:131]
    ds_read_b128 v[156:159], v196 offset:0
    ds_read_b128 v[160:163], v196 offset:4096
    ds_read_b128 v[164:167], v196 offset:8192
    ds_read_b128 v[168:171], v196 offset:12288
    ds_read_b64_tr_b16 v[172:173], v197 offset:24576
    ds_read_b64_tr_b16 v[174:175], v197 offset:26624
    ds_read_b64_tr_b16 v[176:177], v198 offset:24576
    ds_read_b64_tr_b16 v[178:179], v198 offset:26624
    s_waitcnt lgkmcnt(8)
    v_mfma_f32_32x32x16_bf16 v[4:19], v[132:135], v[148:151], v[4:19]
    v_mfma_f32_32x32x16_bf16 v[20:35], v[132:135], v[152:155], v[20:35]
    v_mfma_f32_32x32x16_bf16 v[36:51], v[136:139], v[148:151], v[36:51]
    v_mfma_f32_32x32x16_bf16 v[52:67], v[136:139], v[152:155], v[52:67]
    v_mfma_f32_32x32x16_bf16 v[68:83], v[140:143], v[148:151], v[68:83]
    v_mfma_f32_32x32x16_bf16 v[84:99], v[140:143], v[152:155], v[84:99]
    v_mfma_f32_32x32x16_bf16 v[100:115], v[144:147], v[148:151], v[100:115]
    v_mfma_f32_32x32x16_bf16 v[116:131], v[144:147], v[152:155], v[116:131]
    s_waitcnt lgkmcnt(0)
    v_mfma_f32_32x32x16_bf16 v[4:19], v[156:159], v[172:175], v[4:19]
    v_mfma_f32_32x32x16_bf16 v[20:35], v[156:159], v[176:179], v[20:35]
    v_mfma_f32_32x32x16_bf16 v[36:51], v[160:163], v[172:175], v[36:51]
    v_mfma_f32_32x32x16_bf16 v[52:67], v[160:163], v[176:179], v[52:67]
    s_add_u32 s45, s45, 0x10000
    s_cmp_ge_u32 s45, 0x20000
    s_cselect_b32 s46, 0xffff0000, s48
    s_cselect_b32 s45, 0, s45
    v_add_u32 v193, s46, v193
    v_add_u32 v194, s46, v194
    v_add_u32 v195, s46, v195
    v_add_u32 v196, s46, v196
    v_add_u32 v197, s46, v197
    v_add_u32 v198, s46, v198
    s_waitcnt vmcnt(1)
    s_barrier
    ds_read_b128 v[132:135], v193 offset:0
    ds_read_b128 v[136:139], v193 offset:4096
    ds_read_b128 v[140:143], v193 offset:8192
    ds_read_b128 v[144:147], v193 offset:12288
    ds_read_b64_tr_b16 v[148:149], v197 offset:0
    ds_read_b64_tr_b16 v[150:151], v197 offset:2048
    ds_read_b64_tr_b16 v[152:153], v198 offset:0
    ds_read_b64_tr_b16 v[154:155], v198 offset:2048
    v_mfma_f32_32x32x16_bf16 v[68:83], v[164:167], v[172:175], v[68:83]
    v_mfma_f32_32x32x16_bf16 v[84:99], v[164:167], v[176:179], v[84:99]
    v_mfma_f32_32x32x16_bf16 v[100:115], v[168:171], v[172:175], v[100:115]
    v_mfma_f32_32x32x16_bf16 v[116:131], v[168:171], v[176:179], v[116:131]
    s_mov_b32 s47, 5
kvprep_kernel_v_loop:
    ds_read_b128 v[156:159], v194 offset:0
    ds_read_b128 v[160:163], v194 offset:4096
    ds_read_b128 v[164:167], v194 offset:8192
    ds_read_b128 v[168:171], v194 offset:12288
    ds_read_b64_tr_b16 v[172:173], v197 offset:8192
    ds_read_b64_tr_b16 v[174:175], v197 offset:10240
    ds_read_b64_tr_b16 v[176:177], v198 offset:8192
    ds_read_b64_tr_b16 v[178:179], v198 offset:10240
    s_waitcnt lgkmcnt(8)
    v_mfma_f32_32x32x16_bf16 v[4:19], v[132:135], v[148:151], v[4:19]
    s_add_u32 m0, s44, 0x0
    s_nop 0
    buffer_load_dwordx4 v180, s[4:7], s29 offen lds
    v_mfma_f32_32x32x16_bf16 v[20:35], v[132:135], v[152:155], v[20:35]
    s_add_u32 m0, s44, 0x2000
    s_nop 0
    buffer_load_dwordx4 v181, s[4:7], s29 offen lds
    v_mfma_f32_32x32x16_bf16 v[36:51], v[136:139], v[148:151], v[36:51]
    s_add_u32 m0, s44, 0x4000
    s_nop 0
    buffer_load_dwordx4 v182, s[4:7], s29 offen lds
    v_mfma_f32_32x32x16_bf16 v[52:67], v[136:139], v[152:155], v[52:67]
    s_add_u32 m0, s44, 0x6000
    s_nop 0
    buffer_load_dwordx4 v183, s[4:7], s29 offen lds
    v_mfma_f32_32x32x16_bf16 v[68:83], v[140:143], v[148:151], v[68:83]
    s_add_u32 m0, s44, 0x8000
    s_nop 0
    buffer_load_dwordx4 v184, s[8:11], s30 offen lds
    v_mfma_f32_32x32x16_bf16 v[84:99], v[140:143], v[152:155], v[84:99]
    s_add_u32 m0, s44, 0xa000
    s_nop 0
    buffer_load_dwordx4 v185, s[8:11], s30 offen lds
    v_mfma_f32_32x32x16_bf16 v[100:115], v[144:147], v[148:151], v[100:115]
    s_add_u32 m0, s44, 0xc000
    s_nop 0
    buffer_load_dwordx4 v186, s[8:11], s30 offen lds
    v_mfma_f32_32x32x16_bf16 v[116:131], v[144:147], v[152:155], v[116:131]
    s_add_u32 m0, s44, 0xe000
    s_nop 0
    buffer_load_dwordx4 v187, s[8:11], s30 offen lds
    s_add_u32 s49, s49, 1
    s_cmp_ge_u32 s49, 8
    s_cselect_b32 s49, 0, s49
    s_mul_i32 s30, s49, 64
    s_add_u32 s30, s30, s43
    s_lshl_b32 s29, s30, 1
    s_mul_i32 s30, s30, 8192
    s_add_u32 s44, s44, 0x10000
    s_sub_u32 s46, s44, s31
    s_cmp_ge_u32 s46, 0x20000
    s_cselect_b32 s44, s31, s44
    ds_read_b128 v[132:135], v195 offset:0
    ds_read_b128 v[136:139], v195 offset:4096
    ds_read_b128 v[140:143], v195 offset:8192
    ds_read_b128 v[144:147], v195 offset:12288
    ds_read_b64_tr_b16 v[148:149], v197 offset:16384
    ds_read_b64_tr_b16 v[150:151], v197 offset:18432
    ds_read_b64_tr_b16 v[152:153], v198 offset:16384
    ds_read_b64_tr_b16 v[154:155], v198 offset:18432
    s_waitcnt lgkmcnt(8)
    v_mfma_f32_32x32x16_bf16 v[4:19], v[156:159], v[172:175], v[4:19]
    v_mfma_f32_32x32x16_bf16 v[20:35], v[156:159], v[176:179], v[20:35]
    v_mfma_f32_32x32x16_bf16 v[36:51], v[160:163], v[172:175], v[36:51]
    v_mfma_f32_32x32x16_bf16 v[52:67], v[160:163], v[176:179], v[52:67]
    v_mfma_f32_32x32x16_bf16 v[68:83], v[164:167], v[172:175], v[68:83]
    v_mfma_f32_32x32x16_bf16 v[84:99], v[164:167], v[176:179], v[84:99]
    v_mfma_f32_32x32x16_bf16 v[100:115], v[168:171], v[172:175], v[100:115]
    v_mfma_f32_32x32x16_bf16 v[116:131], v[168:171], v[176:179], v[116:131]
    ds_read_b128 v[156:159], v196 offset:0
    ds_read_b128 v[160:163], v196 offset:4096
    ds_read_b128 v[164:167], v196 offset:8192
    ds_read_b128 v[168:171], v196 offset:12288
    ds_read_b64_tr_b16 v[172:173], v197 offset:24576
    ds_read_b64_tr_b16 v[174:175], v197 offset:26624
    ds_read_b64_tr_b16 v[176:177], v198 offset:24576
    ds_read_b64_tr_b16 v[178:179], v198 offset:26624
    s_waitcnt lgkmcnt(8)
    v_mfma_f32_32x32x16_bf16 v[4:19], v[132:135], v[148:151], v[4:19]
    v_mfma_f32_32x32x16_bf16 v[20:35], v[132:135], v[152:155], v[20:35]
    v_mfma_f32_32x32x16_bf16 v[36:51], v[136:139], v[148:151], v[36:51]
    v_mfma_f32_32x32x16_bf16 v[52:67], v[136:139], v[152:155], v[52:67]
    v_mfma_f32_32x32x16_bf16 v[68:83], v[140:143], v[148:151], v[68:83]
    v_mfma_f32_32x32x16_bf16 v[84:99], v[140:143], v[152:155], v[84:99]
    v_mfma_f32_32x32x16_bf16 v[100:115], v[144:147], v[148:151], v[100:115]
    v_mfma_f32_32x32x16_bf16 v[116:131], v[144:147], v[152:155], v[116:131]
    s_waitcnt lgkmcnt(0)
    v_mfma_f32_32x32x16_bf16 v[4:19], v[156:159], v[172:175], v[4:19]
    v_mfma_f32_32x32x16_bf16 v[20:35], v[156:159], v[176:179], v[20:35]
    v_mfma_f32_32x32x16_bf16 v[36:51], v[160:163], v[172:175], v[36:51]
    v_mfma_f32_32x32x16_bf16 v[52:67], v[160:163], v[176:179], v[52:67]
    s_add_u32 s45, s45, 0x10000
    s_cmp_ge_u32 s45, 0x20000
    s_cselect_b32 s46, 0xffff0000, s48
    s_cselect_b32 s45, 0, s45
    v_add_u32 v193, s46, v193
    v_add_u32 v194, s46, v194
    v_add_u32 v195, s46, v195
    v_add_u32 v196, s46, v196
    v_add_u32 v197, s46, v197
    v_add_u32 v198, s46, v198
    s_waitcnt vmcnt(0)
    s_barrier
    ds_read_b128 v[132:135], v193 offset:0
    ds_read_b128 v[136:139], v193 offset:4096
    ds_read_b128 v[140:143], v193 offset:8192
    ds_read_b128 v[144:147], v193 offset:12288
    ds_read_b64_tr_b16 v[148:149], v197 offset:0
    ds_read_b64_tr_b16 v[150:151], v197 offset:2048
    ds_read_b64_tr_b16 v[152:153], v198 offset:0
    ds_read_b64_tr_b16 v[154:155], v198 offset:2048
    v_mfma_f32_32x32x16_bf16 v[68:83], v[164:167], v[172:175], v[68:83]
    v_mfma_f32_32x32x16_bf16 v[84:99], v[164:167], v[176:179], v[84:99]
    v_mfma_f32_32x32x16_bf16 v[100:115], v[168:171], v[172:175], v[100:115]
    v_mfma_f32_32x32x16_bf16 v[116:131], v[168:171], v[176:179], v[116:131]
    s_sub_u32 s47, s47, 1
    s_cmp_lg_u32 s47, 0
    s_cbranch_scc1 kvprep_kernel_v_loop
    ds_read_b128 v[156:159], v194 offset:0
    ds_read_b128 v[160:163], v194 offset:4096
    ds_read_b128 v[164:167], v194 offset:8192
    ds_read_b128 v[168:171], v194 offset:12288
    ds_read_b64_tr_b16 v[172:173], v197 offset:8192
    ds_read_b64_tr_b16 v[174:175], v197 offset:10240
    ds_read_b64_tr_b16 v[176:177], v198 offset:8192
    ds_read_b64_tr_b16 v[178:179], v198 offset:10240
    s_waitcnt lgkmcnt(8)
    v_mfma_f32_32x32x16_bf16 v[4:19], v[132:135], v[148:151], v[4:19]
    s_add_u32 m0, s44, 0x0
    s_nop 0
    buffer_load_dwordx4 v180, s[4:7], s29 offen lds
    v_mfma_f32_32x32x16_bf16 v[20:35], v[132:135], v[152:155], v[20:35]
    s_add_u32 m0, s44, 0x2000
    s_nop 0
    buffer_load_dwordx4 v181, s[4:7], s29 offen lds
    v_mfma_f32_32x32x16_bf16 v[36:51], v[136:139], v[148:151], v[36:51]
    s_add_u32 m0, s44, 0x4000
    s_nop 0
    buffer_load_dwordx4 v182, s[4:7], s29 offen lds
    v_mfma_f32_32x32x16_bf16 v[52:67], v[136:139], v[152:155], v[52:67]
    s_add_u32 m0, s44, 0x6000
    s_nop 0
    buffer_load_dwordx4 v183, s[4:7], s29 offen lds
    v_mfma_f32_32x32x16_bf16 v[68:83], v[140:143], v[148:151], v[68:83]
    s_add_u32 m0, s44, 0x8000
    s_nop 0
    buffer_load_dwordx4 v184, s[8:11], s30 offen lds
    v_mfma_f32_32x32x16_bf16 v[84:99], v[140:143], v[152:155], v[84:99]
    s_add_u32 m0, s44, 0xa000
    s_nop 0
    buffer_load_dwordx4 v185, s[8:11], s30 offen lds
    v_mfma_f32_32x32x16_bf16 v[100:115], v[144:147], v[148:151], v[100:115]
    s_add_u32 m0, s44, 0xc000
    s_nop 0
    buffer_load_dwordx4 v186, s[8:11], s30 offen lds
    v_mfma_f32_32x32x16_bf16 v[116:131], v[144:147], v[152:155], v[116:131]
    s_add_u32 m0, s44, 0xe000
    s_nop 0
    buffer_load_dwordx4 v187, s[8:11], s30 offen lds
    s_add_u32 s49, s49, 1
    s_cmp_ge_u32 s49, 8
    s_cselect_b32 s49, 0, s49
    s_mul_i32 s30, s49, 64
    s_add_u32 s30, s30, s43
    s_lshl_b32 s29, s30, 1
    s_mul_i32 s30, s30, 8192
    s_add_u32 s44, s44, 0x10000
    s_sub_u32 s46, s44, s31
    s_cmp_ge_u32 s46, 0x20000
    s_cselect_b32 s44, s31, s44
    ds_read_b128 v[132:135], v195 offset:0
    ds_read_b128 v[136:139], v195 offset:4096
    ds_read_b128 v[140:143], v195 offset:8192
    ds_read_b128 v[144:147], v195 offset:12288
    ds_read_b64_tr_b16 v[148:149], v197 offset:16384
    ds_read_b64_tr_b16 v[150:151], v197 offset:18432
    ds_read_b64_tr_b16 v[152:153], v198 offset:16384
    ds_read_b64_tr_b16 v[154:155], v198 offset:18432
    s_waitcnt lgkmcnt(8)
    v_mfma_f32_32x32x16_bf16 v[4:19], v[156:159], v[172:175], v[4:19]
    buffer_load_dwordx4 v[204:207], v200, s[20:23], s26 offen
    v_mfma_f32_32x32x16_bf16 v[20:35], v[156:159], v[176:179], v[20:35]
    buffer_load_dwordx4 v[208:211], v200, s[20:23], s27 offen
    v_mfma_f32_32x32x16_bf16 v[36:51], v[160:163], v[172:175], v[36:51]
    v_mfma_f32_32x32x16_bf16 v[52:67], v[160:163], v[176:179], v[52:67]
    v_mfma_f32_32x32x16_bf16 v[68:83], v[164:167], v[172:175], v[68:83]
    v_mfma_f32_32x32x16_bf16 v[84:99], v[164:167], v[176:179], v[84:99]
    v_mfma_f32_32x32x16_bf16 v[100:115], v[168:171], v[172:175], v[100:115]
    v_mfma_f32_32x32x16_bf16 v[116:131], v[168:171], v[176:179], v[116:131]
    ds_read_b128 v[156:159], v196 offset:0
    ds_read_b128 v[160:163], v196 offset:4096
    ds_read_b128 v[164:167], v196 offset:8192
    ds_read_b128 v[168:171], v196 offset:12288
    ds_read_b64_tr_b16 v[172:173], v197 offset:24576
    ds_read_b64_tr_b16 v[174:175], v197 offset:26624
    ds_read_b64_tr_b16 v[176:177], v198 offset:24576
    ds_read_b64_tr_b16 v[178:179], v198 offset:26624
    s_waitcnt lgkmcnt(8)
    v_mfma_f32_32x32x16_bf16 v[4:19], v[132:135], v[148:151], v[4:19]
    v_mfma_f32_32x32x16_bf16 v[20:35], v[132:135], v[152:155], v[20:35]
    v_mfma_f32_32x32x16_bf16 v[36:51], v[136:139], v[148:151], v[36:51]
    v_mfma_f32_32x32x16_bf16 v[52:67], v[136:139], v[152:155], v[52:67]
    v_mfma_f32_32x32x16_bf16 v[68:83], v[140:143], v[148:151], v[68:83]
    v_mfma_f32_32x32x16_bf16 v[84:99], v[140:143], v[152:155], v[84:99]
    v_mfma_f32_32x32x16_bf16 v[100:115], v[144:147], v[148:151], v[100:115]
    v_mfma_f32_32x32x16_bf16 v[116:131], v[144:147], v[152:155], v[116:131]
    s_waitcnt lgkmcnt(0)
    v_mfma_f32_32x32x16_bf16 v[4:19], v[156:159], v[172:175], v[4:19]
    v_mfma_f32_32x32x16_bf16 v[20:35], v[156:159], v[176:179], v[20:35]
    v_mfma_f32_32x32x16_bf16 v[36:51], v[160:163], v[172:175], v[36:51]
    v_mfma_f32_32x32x16_bf16 v[52:67], v[160:163], v[176:179], v[52:67]
    s_add_u32 s45, s45, 0x10000
    s_cmp_ge_u32 s45, 0x20000
    s_cselect_b32 s46, 0xffff0000, s48
    s_cselect_b32 s45, 0, s45
    v_add_u32 v193, s46, v193
    v_add_u32 v194, s46, v194
    v_add_u32 v195, s46, v195
    v_add_u32 v196, s46, v196
    v_add_u32 v197, s46, v197
    v_add_u32 v198, s46, v198
    s_waitcnt vmcnt(2)
    s_barrier
    ds_read_b128 v[132:135], v193 offset:0
    ds_read_b128 v[136:139], v193 offset:4096
    ds_read_b128 v[140:143], v193 offset:8192
    ds_read_b128 v[144:147], v193 offset:12288
    ds_read_b64_tr_b16 v[148:149], v197 offset:0
    ds_read_b64_tr_b16 v[150:151], v197 offset:2048
    ds_read_b64_tr_b16 v[152:153], v198 offset:0
    ds_read_b64_tr_b16 v[154:155], v198 offset:2048
    v_mfma_f32_32x32x16_bf16 v[68:83], v[164:167], v[172:175], v[68:83]
    v_mfma_f32_32x32x16_bf16 v[84:99], v[164:167], v[176:179], v[84:99]
    v_mfma_f32_32x32x16_bf16 v[100:115], v[168:171], v[172:175], v[100:115]
    v_mfma_f32_32x32x16_bf16 v[116:131], v[168:171], v[176:179], v[116:131]
    s_mul_i32 s37, s35, 128
    s_add_u32 s37, s37, s40
    s_mul_i32 s38, s36, 64
    s_add_u32 s38, s38, s42
    s_lshr_b32 s39, s38, 7
    s_lshl_b32 s39, s39, 19
    s_and_b32 s38, s38, 127
    s_lshl_b32 s38, s38, 8
    s_add_u32 s39, s39, s38
    s_lshl_b32 s37, s37, 8
    s_add_u32 s39, s39, s37
    v_lshl_add_u32 v189, v188, 4, s39
    ds_read_b64_tr_b16 v[212:213], v197 offset:8192
    ds_read_b64_tr_b16 v[214:215], v197 offset:10240
    ds_read_b64_tr_b16 v[216:217], v198 offset:8192
    ds_read_b64_tr_b16 v[218:219], v198 offset:10240
    ds_read_b128 v[156:159], v194 offset:0
    s_waitcnt lgkmcnt(5)
    v_mfma_f32_32x32x16_bf16 v[4:19], v[132:135], v[148:151], v[4:19]
    v_mfma_f32_32x32x16_bf16 v[20:35], v[132:135], v[152:155], v[20:35]
    ds_read_b64_tr_b16 v[220:221], v197 offset:16384
    ds_read_b64_tr_b16 v[222:223], v197 offset:18432
    ds_read_b64_tr_b16 v[224:225], v198 offset:16384
    ds_read_b64_tr_b16 v[226:227], v198 offset:18432
    ds_read_b128 v[160:163], v195 offset:0
    s_waitcnt lgkmcnt(5)
    v_mfma_f32_32x32x16_bf16 v[4:19], v[156:159], v[212:215], v[4:19]
    v_mfma_f32_32x32x16_bf16 v[20:35], v[156:159], v[216:219], v[20:35]
    ds_read_b64_tr_b16 v[228:229], v197 offset:24576
    ds_read_b64_tr_b16 v[230:231], v197 offset:26624
    ds_read_b64_tr_b16 v[232:233], v198 offset:24576
    ds_read_b64_tr_b16 v[234:235], v198 offset:26624
    ds_read_b128 v[164:167], v196 offset:0
    s_waitcnt lgkmcnt(5)
    v_mfma_f32_32x32x16_bf16 v[4:19], v[160:163], v[220:223], v[4:19]
    v_mfma_f32_32x32x16_bf16 v[20:35], v[160:163], v[224:227], v[20:35]
    ds_read_b128 v[168:171], v194 offset:4096
    ds_read_b128 v[172:175], v195 offset:4096
    ds_read_b128 v[176:179], v196 offset:4096
    s_waitcnt lgkmcnt(3)
    v_mfma_f32_32x32x16_bf16 v[4:19], v[164:167], v[228:231], v[4:19]
    v_mfma_f32_32x32x16_bf16 v[20:35], v[164:167], v[232:235], v[20:35]
    ds_read_b128 v[156:159], v194 offset:8192
    ds_read_b128 v[160:163], v195 offset:8192
    ds_read_b128 v[164:167], v196 offset:8192
    v_mfma_f32_32x32x16_bf16 v[36:51], v[136:139], v[148:151], v[36:51]
    v_mfma_f32_32x32x16_bf16 v[52:67], v[136:139], v[152:155], v[52:67]
    s_waitcnt lgkmcnt(3)
    v_mfma_f32_32x32x16_bf16 v[36:51], v[168:171], v[212:215], v[36:51]
    v_cvt_pk_bf16_f32 v236, v4, v5
    v_cvt_pk_bf16_f32 v237, v6, v7
    v_cvt_pk_bf16_f32 v238, v8, v9
    v_cvt_pk_bf16_f32 v239, v10, v11
    s_mov_b32 s39, 0x0
    buffer_store_dwordx4 v[236:239], v189, s[16:19], s39 offen offset:0 sc1
    v_mfma_f32_32x32x16_bf16 v[52:67], v[168:171], v[216:219], v[52:67]
    v_cvt_pk_bf16_f32 v240, v12, v13
    v_cvt_pk_bf16_f32 v241, v14, v15
    v_cvt_pk_bf16_f32 v242, v16, v17
    v_cvt_pk_bf16_f32 v243, v18, v19
    s_mov_b32 s39, 0x0
    buffer_store_dwordx4 v[240:243], v189, s[16:19], s39 offen offset:1024 sc1
    v_mfma_f32_32x32x16_bf16 v[36:51], v[172:175], v[220:223], v[36:51]
    v_cvt_pk_bf16_f32 v244, v20, v21
    v_cvt_pk_bf16_f32 v245, v22, v23
    v_cvt_pk_bf16_f32 v246, v24, v25
    v_cvt_pk_bf16_f32 v247, v26, v27
    s_mov_b32 s39, 0x2000
    buffer_store_dwordx4 v[244:247], v189, s[16:19], s39 offen offset:0 sc1
    v_mfma_f32_32x32x16_bf16 v[52:67], v[172:175], v[224:227], v[52:67]
    v_cvt_pk_bf16_f32 v248, v28, v29
    v_cvt_pk_bf16_f32 v249, v30, v31
    v_cvt_pk_bf16_f32 v250, v32, v33
    v_cvt_pk_bf16_f32 v251, v34, v35
    s_mov_b32 s39, 0x2000
    buffer_store_dwordx4 v[248:251], v189, s[16:19], s39 offen offset:1024 sc1
    v_mfma_f32_32x32x16_bf16 v[36:51], v[176:179], v[228:231], v[36:51]
    v_mfma_f32_32x32x16_bf16 v[52:67], v[176:179], v[232:235], v[52:67]
    ds_read_b128 v[168:171], v194 offset:12288
    ds_read_b128 v[172:175], v195 offset:12288
    ds_read_b128 v[176:179], v196 offset:12288
    v_mfma_f32_32x32x16_bf16 v[68:83], v[140:143], v[148:151], v[68:83]
    v_mfma_f32_32x32x16_bf16 v[84:99], v[140:143], v[152:155], v[84:99]
    s_waitcnt lgkmcnt(3)
    v_mfma_f32_32x32x16_bf16 v[68:83], v[156:159], v[212:215], v[68:83]
    v_cvt_pk_bf16_f32 v236, v36, v37
    v_cvt_pk_bf16_f32 v237, v38, v39
    v_cvt_pk_bf16_f32 v238, v40, v41
    v_cvt_pk_bf16_f32 v239, v42, v43
    s_mov_b32 s39, 0x0
    buffer_store_dwordx4 v[236:239], v189, s[16:19], s39 offen offset:2048 sc1
    v_mfma_f32_32x32x16_bf16 v[84:99], v[156:159], v[216:219], v[84:99]
    v_cvt_pk_bf16_f32 v240, v44, v45
    v_cvt_pk_bf16_f32 v241, v46, v47
    v_cvt_pk_bf16_f32 v242, v48, v49
    v_cvt_pk_bf16_f32 v243, v50, v51
    s_mov_b32 s39, 0x0
    buffer_store_dwordx4 v[240:243], v189, s[16:19], s39 offen offset:3072 sc1
    v_mfma_f32_32x32x16_bf16 v[68:83], v[160:163], v[220:223], v[68:83]
    v_cvt_pk_bf16_f32 v244, v52, v53
    v_cvt_pk_bf16_f32 v245, v54, v55
    v_cvt_pk_bf16_f32 v246, v56, v57
    v_cvt_pk_bf16_f32 v247, v58, v59
    s_mov_b32 s39, 0x2000
    buffer_store_dwordx4 v[244:247], v189, s[16:19], s39 offen offset:2048 sc1
    v_mfma_f32_32x32x16_bf16 v[84:99], v[160:163], v[224:227], v[84:99]
    v_cvt_pk_bf16_f32 v248, v60, v61
    v_cvt_pk_bf16_f32 v249, v62, v63
    v_cvt_pk_bf16_f32 v250, v64, v65
    v_cvt_pk_bf16_f32 v251, v66, v67
    s_mov_b32 s39, 0x2000
    buffer_store_dwordx4 v[248:251], v189, s[16:19], s39 offen offset:3072 sc1
    v_mfma_f32_32x32x16_bf16 v[68:83], v[164:167], v[228:231], v[68:83]
    v_mfma_f32_32x32x16_bf16 v[84:99], v[164:167], v[232:235], v[84:99]
    v_mfma_f32_32x32x16_bf16 v[100:115], v[144:147], v[148:151], v[100:115]
    v_mfma_f32_32x32x16_bf16 v[116:131], v[144:147], v[152:155], v[116:131]
    s_waitcnt lgkmcnt(0)
    v_mfma_f32_32x32x16_bf16 v[100:115], v[168:171], v[212:215], v[100:115]
    v_cvt_pk_bf16_f32 v236, v68, v69
    v_cvt_pk_bf16_f32 v237, v70, v71
    v_cvt_pk_bf16_f32 v238, v72, v73
    v_cvt_pk_bf16_f32 v239, v74, v75
    s_mov_b32 s39, 0x1000
    buffer_store_dwordx4 v[236:239], v189, s[16:19], s39 offen offset:0 sc1
    v_mfma_f32_32x32x16_bf16 v[116:131], v[168:171], v[216:219], v[116:131]
    v_cvt_pk_bf16_f32 v240, v76, v77
    v_cvt_pk_bf16_f32 v241, v78, v79
    v_cvt_pk_bf16_f32 v242, v80, v81
    v_cvt_pk_bf16_f32 v243, v82, v83
    s_mov_b32 s39, 0x1000
    buffer_store_dwordx4 v[240:243], v189, s[16:19], s39 offen offset:1024 sc1
    v_mfma_f32_32x32x16_bf16 v[100:115], v[172:175], v[220:223], v[100:115]
    v_cvt_pk_bf16_f32 v244, v84, v85
    v_cvt_pk_bf16_f32 v245, v86, v87
    v_cvt_pk_bf16_f32 v246, v88, v89
    v_cvt_pk_bf16_f32 v247, v90, v91
    s_mov_b32 s39, 0x3000
    buffer_store_dwordx4 v[244:247], v189, s[16:19], s39 offen offset:0 sc1
    v_mfma_f32_32x32x16_bf16 v[116:131], v[172:175], v[224:227], v[116:131]
    v_cvt_pk_bf16_f32 v248, v92, v93
    v_cvt_pk_bf16_f32 v249, v94, v95
    v_cvt_pk_bf16_f32 v250, v96, v97
    v_cvt_pk_bf16_f32 v251, v98, v99
    s_mov_b32 s39, 0x3000
    buffer_store_dwordx4 v[248:251], v189, s[16:19], s39 offen offset:1024 sc1
    v_mfma_f32_32x32x16_bf16 v[100:115], v[176:179], v[228:231], v[100:115]
    v_mfma_f32_32x32x16_bf16 v[116:131], v[176:179], v[232:235], v[116:131]
    s_nop 15
    s_nop 3
    v_cvt_pk_bf16_f32 v236, v100, v101
    v_cvt_pk_bf16_f32 v237, v102, v103
    v_cvt_pk_bf16_f32 v238, v104, v105
    v_cvt_pk_bf16_f32 v239, v106, v107
    s_mov_b32 s39, 0x1000
    buffer_store_dwordx4 v[236:239], v189, s[16:19], s39 offen offset:2048 sc1
    v_cvt_pk_bf16_f32 v240, v108, v109
    v_cvt_pk_bf16_f32 v241, v110, v111
    v_cvt_pk_bf16_f32 v242, v112, v113
    v_cvt_pk_bf16_f32 v243, v114, v115
    s_mov_b32 s39, 0x1000
    buffer_store_dwordx4 v[240:243], v189, s[16:19], s39 offen offset:3072 sc1
    v_cvt_pk_bf16_f32 v244, v116, v117
    v_cvt_pk_bf16_f32 v245, v118, v119
    v_cvt_pk_bf16_f32 v246, v120, v121
    v_cvt_pk_bf16_f32 v247, v122, v123
    s_mov_b32 s39, 0x3000
    buffer_store_dwordx4 v[244:247], v189, s[16:19], s39 offen offset:2048 sc1
    v_cvt_pk_bf16_f32 v248, v124, v125
    v_cvt_pk_bf16_f32 v249, v126, v127
    v_cvt_pk_bf16_f32 v250, v128, v129
    v_cvt_pk_bf16_f32 v251, v130, v131
    s_mov_b32 s39, 0x3000
    buffer_store_dwordx4 v[248:251], v189, s[16:19], s39 offen offset:3072 sc1
    s_waitcnt vmcnt(0)
    s_endpgm
.text
.globl attn_kernel
.p2align 8
.type attn_kernel,@function
attn_kernel:
    s_cmp_ge_u32 s2, 256
    s_cbranch_scc1 attn_kernel_end
    s_load_dwordx2 s[20:21], s[0:1], 112
    s_load_dwordx2 s[52:53], s[0:1], 40
    s_load_dwordx2 s[54:55], s[0:1], 56
    s_load_dwordx2 s[56:57], s[0:1], 64
    s_load_dwordx2 s[58:59], s[0:1], 72
    s_load_dwordx2 s[22:23], s[0:1], 16
    s_waitcnt lgkmcnt(0)
    s_mul_i32 s36, s2, 16384
    s_add_u32 s60, s52, s36
    s_addc_u32 s61, s53, 0
    s_sub_u32 s62, 0x400000, s36
    s_mov_b32 s63, 0x00020000
    s_mul_i32 s36, s2, 16384
    s_add_u32 s36, s36, 8192
    s_add_u32 s64, s52, s36
    s_addc_u32 s65, s53, 0
    s_sub_u32 s66, 0x400000, s36
    s_mov_b32 s67, 0x00020000
    s_mul_i32 s36, s2, 7168
    s_add_u32 s68, s54, s36
    s_addc_u32 s69, s55, 0
    s_sub_u32 s70, 0x1c0000, s36
    s_mov_b32 s71, 0x00020000
    s_mul_i32 s36, s2, 7168
    s_add_u32 s72, s56, s36
    s_addc_u32 s73, s57, 0
    s_sub_u32 s74, 0x1c0000, s36
    s_mov_b32 s75, 0x00020000
    s_mul_i32 s36, s2, 7168
    s_add_u32 s76, s58, s36
    s_addc_u32 s77, s59, 0
    s_sub_u32 s78, 0x1c0000, s36
    s_mov_b32 s79, 0x00020000
    s_add_u32 s4, s20, 0x100000
    s_addc_u32 s5, s21, 0
    s_mov_b32 s6, 0x200000
    s_mov_b32 s7, 0x00020000
    s_mov_b32 s8, s22
    s_mov_b32 s9, s23
    s_mov_b32 s10, 0x400000
    s_mov_b32 s11, 0x00020000
    s_add_u32 s24, s20, 0x1400000
    s_addc_u32 s25, s21, 0
    s_mov_b32 s26, 0x1000000
    s_mov_b32 s27, 0x00020000
    s_add_u32 s12, s20, 0x2400000
    s_addc_u32 s13, s21, 0
    s_mov_b32 s14, 0x1000000
    s_mov_b32 s15, 0x00020000
    s_add_u32 s16, s20, 0x3400000
    s_addc_u32 s17, s21, 0
    s_mov_b32 s18, 0x1000000
    s_mov_b32 s19, 0x00020000
    v_lshrrev_b32 v1, 6, v0
    v_and_b32 v241, 63, v0
    s_nop 0
    v_readfirstlane_b32 s28, v1
    s_lshl_b32 s31, s28, 10
    s_lshr_b32 s33, s28, 2
    s_and_b32 s34, s28, 3
    s_and_b32 s40, s2, 7
    s_lshl_b32 s40, s40, 2
    s_lshr_b32 s35, s2, 3
    s_and_b32 s35, s35, 3
    s_add_u32 s40, s40, s35
    s_lshr_b32 s48, s2, 5
    s_sub_u32 s41, 16, s48
    s_sub_u32 s43, 15, s48
    s_lshl_b32 s49, s43, 20
    s_lshl_b32 s47, s48, 20
    s_sub_u32 s39, s41, 2
    s_mov_b32 s46, 0x3e0293ee
    v_mov_b32 v238, 0xff800000
    v_mov_b32 v231, 0
    s_mov_b32 s81, 0x3f803f80
    v_mov_b32 v212, 0
    v_mov_b32 v213, 0
    v_mov_b32 v214, 0
    v_mov_b32 v215, 0
    v_mov_b32 v216, 0
    v_mov_b32 v217, 0
    v_mov_b32 v218, 0
    v_mov_b32 v219, 0
    v_mov_b32 v220, 0
    v_mov_b32 v221, 0
    v_mov_b32 v222, 0
    v_mov_b32 v223, 0
    v_mov_b32 v224, 0
    v_mov_b32 v225, 0
    v_mov_b32 v226, 0
    v_mov_b32 v227, 0
    s_lshl_b32 s35, s40, 19
    s_add_u32 s35, s35, s31
    v_lshl_add_u32 v240, v241, 4, s35
    v_lshrrev_b32 v2, 5, v241
    s_lshl_b32 s35, s33, 14
    v_lshl_add_u32 v228, v241, 4, s35
    s_lshl_b32 s35, s33, 12
    s_add_u32 s35, s35, 0x10000
    v_lshl_add_u32 v230, v241, 4, s35
    s_lshl_b32 s35, s34, 13
    s_add_u32 s35, s35, 0x18000
    v_lshl_add_u32 v229, v241, 4, s35
    v_and_b32 v1, 31, v241
    s_lshl_b32 s35, s34, 5
    s_lshl_b32 s36, s33, 6
    s_sub_u32 s35, s35, s36
    v_lshlrev_b32 v3, 2, v2
    v_sub_u32 v239, v1, v3
    v_add_u32 v239, s35, v239
    s_lshl_b32 s35, s34, 18
    s_lshl_b32 s36, s40, 13
    s_add_u32 s35, s35, s36
    s_lshl_b32 s36, s33, 12
    s_add_u32 s35, s35, s36
    v_lshl_add_u32 v242, v241, 4, s35
    s_lshl_b32 s41, s40, 7
    s_mov_b32 s42, s41
    s_lshl_b32 s40, s43, 7
    s_sub_u32 s51, s48, s43
    s_sub_u32 s51, s51, 1
    s_lshl_b32 s51, s51, 17
    s_lshl_b32 s52, s48, 13
    v_lshrrev_b32 v1, 6, v0
    v_and_b32 v106, 63, v0
    s_nop 0
    v_readfirstlane_b32 s28, v1
    s_lshl_b32 s31, s28, 10
    s_lshr_b32 s33, s28, 3
    s_and_b32 s34, s28, 7
    s_and_b32 s35, s34, 3
    s_lshr_b32 s36, s34, 2
    v_lshrrev_b32 v107, 3, v106
    s_mul_i32 s37, s28, 8
    v_add_u32 v107, s37, v107
    v_and_b32 v108, 7, v106
    v_lshrrev_b32 v109, 1, v107
    v_and_b32 v109, 7, v109
    v_xor_b32 v108, v108, v109
    v_lshlrev_b32 v108, 4, v108
    v_add_u32 v107, s40, v107
    s_mov_b32 s37, 1024
    v_mul_lo_u32 v107, v107, s37
    v_add_u32 v100, v107, v108
    v_add_u32 v101, 0x10000, v100
    v_add_u32 v102, 0x20000, v100
    v_add_u32 v102, s51, v102
    v_add_u32 v103, 0x30000, v100
    v_add_u32 v103, s51, v103
    v_lshrrev_b32 v107, 4, v106
    s_mul_i32 s37, s28, 4
    v_add_u32 v107, s37, v107
    v_and_b32 v108, 15, v106
    v_and_b32 v109, 3, v107
    v_lshlrev_b32 v109, 2, v109
    v_xor_b32 v108, v108, v109
    v_lshlrev_b32 v108, 4, v108
    s_mov_b32 s37, 8192
    v_mul_lo_u32 v107, v107, s37
    s_lshl_b32 s37, s41, 1
    v_add3_u32 v104, v107, v108, s37
    v_add_u32 v105, 0x40000, v104
    s_mov_b32 s43, 0
    s_mov_b32 s49, 0
    s_mul_i32 s30, s49, 64
    s_add_u32 s30, s30, s43
    s_lshl_b32 s29, s30, 1
    s_mul_i32 s30, s30, 8192
    s_add_u32 s44, s31, 0xc000
    s_add_u32 m0, s44, 0x0
    s_nop 0
    buffer_load_dwordx4 v100, s[4:7], s29 offen lds
    s_add_u32 m0, s44, 0x2000
    s_nop 0
    buffer_load_dwordx4 v101, s[4:7], s29 offen lds
    s_add_u32 m0, s44, 0x4000
    s_nop 0
    buffer_load_dwordx4 v102, s[4:7], s29 offen lds
    s_add_u32 m0, s44, 0x6000
    s_nop 0
    buffer_load_dwordx4 v103, s[4:7], s29 offen lds
    s_add_u32 m0, s44, 0x8000
    s_nop 0
    buffer_load_dwordx4 v104, s[8:11], s30 offen lds
    s_add_u32 m0, s44, 0xa000
    s_nop 0
    buffer_load_dwordx4 v105, s[8:11], s30 offen lds
    s_add_u32 s49, s49, 1
    s_cmp_ge_u32 s49, 8
    s_cselect_b32 s49, 0, s49
    s_mul_i32 s30, s49, 64
    s_add_u32 s30, s30, s43
    s_lshl_b32 s29, s30, 1
    s_mul_i32 s30, s30, 8192
    s_add_u32 s44, s31, 0x18000
    s_add_u32 m0, s44, 0x0
    s_nop 0
    buffer_load_dwordx4 v100, s[4:7], s29 offen lds
    s_add_u32 m0, s44, 0x2000
    s_nop 0
    buffer_load_dwordx4 v101, s[4:7], s29 offen lds
    s_add_u32 m0, s44, 0x4000
    s_nop 0
    buffer_load_dwordx4 v102, s[4:7], s29 offen lds
    s_add_u32 m0, s44, 0x6000
    s_nop 0
    buffer_load_dwordx4 v103, s[4:7], s29 offen lds
    s_add_u32 m0, s44, 0x8000
    s_nop 0
    buffer_load_dwordx4 v104, s[8:11], s30 offen lds
    s_add_u32 m0, s44, 0xa000
    s_nop 0
    buffer_load_dwordx4 v105, s[8:11], s30 offen lds
    s_add_u32 s49, s49, 1
    s_cmp_ge_u32 s49, 8
    s_cselect_b32 s49, 0, s49
    s_mul_i32 s30, s49, 64
    s_add_u32 s30, s30, s43
    s_lshl_b32 s29, s30, 1
    s_mul_i32 s30, s30, 8192
    s_add_u32 s44, s31, 0x0
    s_add_u32 m0, s44, 0x0
    s_nop 0
    buffer_load_dwordx4 v100, s[4:7], s29 offen lds
    s_add_u32 m0, s44, 0x2000
    s_nop 0
    buffer_load_dwordx4 v101, s[4:7], s29 offen lds
    s_add_u32 m0, s44, 0x4000
    s_nop 0
    buffer_load_dwordx4 v102, s[4:7], s29 offen lds
    s_add_u32 m0, s44, 0x6000
    s_nop 0
    buffer_load_dwordx4 v103, s[4:7], s29 offen lds
    s_add_u32 m0, s44, 0x8000
    s_nop 0
    buffer_load_dwordx4 v104, s[8:11], s30 offen lds
    s_add_u32 m0, s44, 0xa000
    s_nop 0
    buffer_load_dwordx4 v105, s[8:11], s30 offen lds
    s_add_u32 s49, s49, 1
    s_cmp_ge_u32 s49, 8
    s_cselect_b32 s49, 0, s49
    s_mul_i32 s30, s49, 64
    s_add_u32 s30, s30, s43
    s_lshl_b32 s29, s30, 1
    s_mul_i32 s30, s30, 8192
    s_add_u32 s44, s31, 0xc000
    s_mov_b32 s45, 0xc000
    s_mov_b32 s48, 0xc000
    v_and_b32 v107, 31, v106
    v_lshrrev_b32 v108, 5, v106
    v_lshrrev_b32 v109, 1, v107
    v_and_b32 v109, 7, v109
    s_mul_i32 s37, s35, 64
    v_add_u32 v107, s37, v107
    v_lshlrev_b32 v107, 7, v107
    s_mul_i32 s37, s33, 8
    v_add_u32 v108, s37, v108
    v_add_u32 v110, 0, v108
    v_xor_b32 v110, v110, v109
    v_lshl_add_u32 v111, v110, 4, v107
    v_add_u32 v111, 0xc000, v111
    v_add_u32 v110, 2, v108
    v_xor_b32 v110, v110, v109
    v_lshl_add_u32 v112, v110, 4, v107
    v_add_u32 v112, 0xc000, v112
    v_add_u32 v110, 4, v108
    v_xor_b32 v110, v110, v109
    v_lshl_add_u32 v113, v110, 4, v107
    v_add_u32 v113, 0xc000, v113
    v_add_u32 v110, 6, v108
    v_xor_b32 v110, v110, v109
    v_lshl_add_u32 v114, v110, 4, v107
    v_add_u32 v114, 0xc000, v114
    v_bfe_u32 v107, v106, 2, 2
    v_lshrrev_b32 v108, 5, v106
    v_lshlrev_b32 v108, 3, v108
    v_add_u32 v108, v108, v107
    s_mul_i32 s37, s33, 64
    v_add_u32 v108, s37, v108
    v_lshlrev_b32 v108, 8, v108
    v_and_b32 v109, 3, v106
    v_lshlrev_b32 v109, 3, v109
    v_add_u32 v108, v108, v109
    v_bfe_u32 v109, v106, 4, 1
    v_lshlrev_b32 v109, 5, v109
    v_add_u32 v108, v108, v109
    s_mul_i32 s37, s36, 2
    s_add_u32 s38, s37, 0
    v_xor_b32 v109, s38, v107
    v_lshl_add_u32 v109, v109, 6, v108
    v_add_u32 v115, 0x14000, v109
    s_add_u32 s38, s37, 1
    v_xor_b32 v109, s38, v107
    v_lshl_add_u32 v109, v109, 6, v108
    v_add_u32 v116, 0x14000, v109
    s_waitcnt vmcnt(12)
    s_barrier
    ds_read_b128 v[68:71], v111 offset:0
    ds_read_b128 v[72:75], v111 offset:4096
    ds_read_b64_tr_b16 v[76:77], v115 offset:0
    ds_read_b64_tr_b16 v[78:79], v115 offset:1024
    ds_read_b64_tr_b16 v[80:81], v116 offset:0
    ds_read_b64_tr_b16 v[82:83], v116 offset:1024
    ds_read_b128 v[84:87], v112 offset:0
    ds_read_b128 v[88:91], v112 offset:4096
    ds_read_b64_tr_b16 v[92:93], v115 offset:4096
    ds_read_b64_tr_b16 v[94:95], v115 offset:5120
    ds_read_b64_tr_b16 v[96:97], v116 offset:4096
    ds_read_b64_tr_b16 v[98:99], v116 offset:5120
    s_waitcnt lgkmcnt(6)
    v_mfma_f32_32x32x16_bf16 v[4:19], v[76:79], v[68:71], 0
    v_mfma_f32_32x32x16_bf16 v[20:35], v[80:83], v[68:71], 0
    v_mfma_f32_32x32x16_bf16 v[36:51], v[76:79], v[72:75], 0
    v_mfma_f32_32x32x16_bf16 v[52:67], v[80:83], v[72:75], 0
    ds_read_b128 v[68:71], v113 offset:0
    ds_read_b128 v[72:75], v113 offset:4096
    ds_read_b64_tr_b16 v[76:77], v115 offset:8192
    ds_read_b64_tr_b16 v[78:79], v115 offset:9216
    ds_read_b64_tr_b16 v[80:81], v116 offset:8192
    ds_read_b64_tr_b16 v[82:83], v116 offset:9216
    s_waitcnt lgkmcnt(6)
    v_mfma_f32_32x32x16_bf16 v[4:19], v[92:95], v[84:87], v[4:19]
    v_mfma_f32_32x32x16_bf16 v[20:35], v[96:99], v[84:87], v[20:35]
    v_mfma_f32_32x32x16_bf16 v[36:51], v[92:95], v[88:91], v[36:51]
    v_mfma_f32_32x32x16_bf16 v[52:67], v[96:99], v[88:91], v[52:67]
    ds_read_b128 v[84:87], v114 offset:0
    ds_read_b128 v[88:91], v114 offset:4096
    ds_read_b64_tr_b16 v[92:93], v115 offset:12288
    ds_read_b64_tr_b16 v[94:95], v115 offset:13312
    ds_read_b64_tr_b16 v[96:97], v116 offset:12288
    ds_read_b64_tr_b16 v[98:99], v116 offset:13312
    s_waitcnt lgkmcnt(6)
    v_mfma_f32_32x32x16_bf16 v[4:19], v[76:79], v[68:71], v[4:19]
    v_mfma_f32_32x32x16_bf16 v[20:35], v[80:83], v[68:71], v[20:35]
    v_mfma_f32_32x32x16_bf16 v[36:51], v[76:79], v[72:75], v[36:51]
    v_mfma_f32_32x32x16_bf16 v[52:67], v[80:83], v[72:75], v[52:67]
    s_waitcnt lgkmcnt(0)
    v_mfma_f32_32x32x16_bf16 v[4:19], v[92:95], v[84:87], v[4:19]
    v_mfma_f32_32x32x16_bf16 v[20:35], v[96:99], v[84:87], v[20:35]
    s_add_u32 s45, s45, 0xc000
    s_cmp_ge_u32 s45, 0x24000
    s_cselect_b32 s46, 0xfffe8000, s48
    s_cselect_b32 s45, 0, s45
    v_add_u32 v111, s46, v111
    v_add_u32 v112, s46, v112
    v_add_u32 v113, s46, v113
    v_add_u32 v114, s46, v114
    v_add_u32 v115, s46, v115
    v_add_u32 v116, s46, v116
    s_waitcnt vmcnt(6)
    s_barrier
    ds_read_b128 v[68:71], v111 offset:0
    ds_read_b128 v[72:75], v111 offset:4096
    ds_read_b64_tr_b16 v[76:77], v115 offset:0
    ds_read_b64_tr_b16 v[78:79], v115 offset:1024
    ds_read_b64_tr_b16 v[80:81], v116 offset:0
    ds_read_b64_tr_b16 v[82:83], v116 offset:1024
    v_mfma_f32_32x32x16_bf16 v[36:51], v[92:95], v[88:91], v[36:51]
    v_mfma_f32_32x32x16_bf16 v[52:67], v[96:99], v[88:91], v[52:67]
    s_mov_b32 s47, 5
attn_kernel_q_loop:
    ds_read_b128 v[84:87], v112 offset:0
    ds_read_b128 v[88:91], v112 offset:4096
    ds_read_b64_tr_b16 v[92:93], v115 offset:4096
    ds_read_b64_tr_b16 v[94:95], v115 offset:5120
    ds_read_b64_tr_b16 v[96:97], v116 offset:4096
    ds_read_b64_tr_b16 v[98:99], v116 offset:5120
    s_waitcnt lgkmcnt(6)
    v_mfma_f32_32x32x16_bf16 v[4:19], v[76:79], v[68:71], v[4:19]
    s_add_u32 m0, s44, 0x0
    s_nop 0
    buffer_load_dwordx4 v100, s[4:7], s29 offen lds
    v_mfma_f32_32x32x16_bf16 v[20:35], v[80:83], v[68:71], v[20:35]
    s_add_u32 m0, s44, 0x2000
    s_nop 0
    buffer_load_dwordx4 v101, s[4:7], s29 offen lds
    v_mfma_f32_32x32x16_bf16 v[36:51], v[76:79], v[72:75], v[36:51]
    s_add_u32 m0, s44, 0x4000
    s_nop 0
    buffer_load_dwordx4 v102, s[4:7], s29 offen lds
    v_mfma_f32_32x32x16_bf16 v[52:67], v[80:83], v[72:75], v[52:67]
    s_add_u32 m0, s44, 0x6000
    s_nop 0
    buffer_load_dwordx4 v103, s[4:7], s29 offen lds
    ds_read_b128 v[68:71], v113 offset:0
    ds_read_b128 v[72:75], v113 offset:4096
    ds_read_b64_tr_b16 v[76:77], v115 offset:8192
    ds_read_b64_tr_b16 v[78:79], v115 offset:9216
    ds_read_b64_tr_b16 v[80:81], v116 offset:8192
    ds_read_b64_tr_b16 v[82:83], v116 offset:9216
    s_waitcnt lgkmcnt(6)
    v_mfma_f32_32x32x16_bf16 v[4:19], v[92:95], v[84:87], v[4:19]
    s_add_u32 m0, s44, 0x8000
    s_nop 0
    buffer_load_dwordx4 v104, s[8:11], s30 offen lds
    v_mfma_f32_32x32x16_bf16 v[20:35], v[96:99], v[84:87], v[20:35]
    s_add_u32 m0, s44, 0xa000
    s_nop 0
    buffer_load_dwordx4 v105, s[8:11], s30 offen lds
    s_add_u32 s49, s49, 1
    s_cmp_ge_u32 s49, 8
    s_cselect_b32 s49, 0, s49
    s_mul_i32 s30, s49, 64
    s_add_u32 s30, s30, s43
    s_lshl_b32 s29, s30, 1
    s_mul_i32 s30, s30, 8192
    s_add_u32 s44, s44, 0xc000
    s_sub_u32 s46, s44, s31
    s_cmp_ge_u32 s46, 0x24000
    s_cselect_b32 s44, s31, s44
    v_mfma_f32_32x32x16_bf16 v[36:51], v[92:95], v[88:91], v[36:51]
    v_mfma_f32_32x32x16_bf16 v[52:67], v[96:99], v[88:91], v[52:67]
    ds_read_b128 v[84:87], v114 offset:0
    ds_read_b128 v[88:91], v114 offset:4096
    ds_read_b64_tr_b16 v[92:93], v115 offset:12288
    ds_read_b64_tr_b16 v[94:95], v115 offset:13312
    ds_read_b64_tr_b16 v[96:97], v116 offset:12288
    ds_read_b64_tr_b16 v[98:99], v116 offset:13312
    s_waitcnt lgkmcnt(6)
    v_mfma_f32_32x32x16_bf16 v[4:19], v[76:79], v[68:71], v[4:19]
    v_mfma_f32_32x32x16_bf16 v[20:35], v[80:83], v[68:71], v[20:35]
    v_mfma_f32_32x32x16_bf16 v[36:51], v[76:79], v[72:75], v[36:51]
    v_mfma_f32_32x32x16_bf16 v[52:67], v[80:83], v[72:75], v[52:67]
    s_waitcnt lgkmcnt(0)
    v_mfma_f32_32x32x16_bf16 v[4:19], v[92:95], v[84:87], v[4:19]
    v_mfma_f32_32x32x16_bf16 v[20:35], v[96:99], v[84:87], v[20:35]
    s_add_u32 s45, s45, 0xc000
    s_cmp_ge_u32 s45, 0x24000
    s_cselect_b32 s46, 0xfffe8000, s48
    s_cselect_b32 s45, 0, s45
    v_add_u32 v111, s46, v111
    v_add_u32 v112, s46, v112
    v_add_u32 v113, s46, v113
    v_add_u32 v114, s46, v114
    v_add_u32 v115, s46, v115
    v_add_u32 v116, s46, v116
    s_waitcnt vmcnt(6)
    s_barrier
    ds_read_b128 v[68:71], v111 offset:0
    ds_read_b128 v[72:75], v111 offset:4096
    ds_read_b64_tr_b16 v[76:77], v115 offset:0
    ds_read_b64_tr_b16 v[78:79], v115 offset:1024
    ds_read_b64_tr_b16 v[80:81], v116 offset:0
    ds_read_b64_tr_b16 v[82:83], v116 offset:1024
    v_mfma_f32_32x32x16_bf16 v[36:51], v[92:95], v[88:91], v[36:51]
    v_mfma_f32_32x32x16_bf16 v[52:67], v[96:99], v[88:91], v[52:67]
    s_sub_u32 s47, s47, 1
    s_cmp_lg_u32 s47, 0
    s_cbranch_scc1 attn_kernel_q_loop
    ds_read_b128 v[84:87], v112 offset:0
    ds_read_b128 v[88:91], v112 offset:4096
    ds_read_b64_tr_b16 v[92:93], v115 offset:4096
    ds_read_b64_tr_b16 v[94:95], v115 offset:5120
    ds_read_b64_tr_b16 v[96:97], v116 offset:4096
    ds_read_b64_tr_b16 v[98:99], v116 offset:5120
    s_waitcnt lgkmcnt(6)
    v_mfma_f32_32x32x16_bf16 v[4:19], v[76:79], v[68:71], v[4:19]
    s_mov_b32 s50, 0x0
    s_add_u32 m0, s31, 0x0
    s_nop 0
    buffer_load_dwordx4 v240, s[24:27], s50 offen lds
    v_mfma_f32_32x32x16_bf16 v[20:35], v[80:83], v[68:71], v[20:35]
    s_mov_b32 s50, 0x2000
    s_add_u32 m0, s31, 0x2000
    s_nop 0
    buffer_load_dwordx4 v240, s[24:27], s50 offen lds
    v_mfma_f32_32x32x16_bf16 v[36:51], v[76:79], v[72:75], v[36:51]
    s_mov_b32 s50, 0x4000
    s_add_u32 m0, s31, 0x4000
    s_nop 0
    buffer_load_dwordx4 v240, s[24:27], s50 offen lds
    v_mfma_f32_32x32x16_bf16 v[52:67], v[80:83], v[72:75], v[52:67]
    s_mov_b32 s50, 0x6000
    s_add_u32 m0, s31, 0x6000
    s_nop 0
    buffer_load_dwordx4 v240, s[24:27], s50 offen lds
    ds_read_b128 v[68:71], v113 offset:0
    ds_read_b128 v[72:75], v113 offset:4096
    ds_read_b64_tr_b16 v[76:77], v115 offset:8192
    ds_read_b64_tr_b16 v[78:79], v115 offset:9216
    ds_read_b64_tr_b16 v[80:81], v116 offset:8192
    ds_read_b64_tr_b16 v[82:83], v116 offset:9216
    s_waitcnt lgkmcnt(6)
    v_mfma_f32_32x32x16_bf16 v[4:19], v[92:95], v[84:87], v[4:19]
    s_mov_b32 s50, 0x8000
    s_add_u32 m0, s31, 0x8000
    s_nop 0
    buffer_load_dwordx4 v240, s[24:27], s50 offen lds
    v_mfma_f32_32x32x16_bf16 v[20:35], v[96:99], v[84:87], v[20:35]
    s_mov_b32 s50, 0xa000
    s_add_u32 m0, s31, 0xa000
    s_nop 0
    buffer_load_dwordx4 v240, s[24:27], s50 offen lds
    v_mfma_f32_32x32x16_bf16 v[36:51], v[92:95], v[88:91], v[36:51]
    v_mfma_f32_32x32x16_bf16 v[52:67], v[96:99], v[88:91], v[52:67]
    ds_read_b128 v[84:87], v114 offset:0
    ds_read_b128 v[88:91], v114 offset:4096
    ds_read_b64_tr_b16 v[92:93], v115 offset:12288
    ds_read_b64_tr_b16 v[94:95], v115 offset:13312
    ds_read_b64_tr_b16 v[96:97], v116 offset:12288
    ds_read_b64_tr_b16 v[98:99], v116 offset:13312
    s_waitcnt lgkmcnt(6)
    v_mfma_f32_32x32x16_bf16 v[4:19], v[76:79], v[68:71], v[4:19]
    v_mfma_f32_32x32x16_bf16 v[20:35], v[80:83], v[68:71], v[20:35]
    v_mfma_f32_32x32x16_bf16 v[36:51], v[76:79], v[72:75], v[36:51]
    v_mfma_f32_32x32x16_bf16 v[52:67], v[80:83], v[72:75], v[52:67]
    s_waitcnt lgkmcnt(0)
    v_mfma_f32_32x32x16_bf16 v[4:19], v[92:95], v[84:87], v[4:19]
    v_mfma_f32_32x32x16_bf16 v[20:35], v[96:99], v[84:87], v[20:35]
    s_add_u32 s45, s45, 0xc000
    s_cmp_ge_u32 s45, 0x24000
    s_cselect_b32 s46, 0xfffe8000, s48
    s_cselect_b32 s45, 0, s45
    v_add_u32 v111, s46, v111
    v_add_u32 v112, s46, v112
    v_add_u32 v113, s46, v113
    v_add_u32 v114, s46, v114
    v_add_u32 v115, s46, v115
    v_add_u32 v116, s46, v116
    s_waitcnt vmcnt(6)
    s_barrier
    ds_read_b128 v[68:71], v111 offset:0
    ds_read_b128 v[72:75], v111 offset:4096
    ds_read_b64_tr_b16 v[76:77], v115 offset:0
    ds_read_b64_tr_b16 v[78:79], v115 offset:1024
    ds_read_b64_tr_b16 v[80:81], v116 offset:0
    ds_read_b64_tr_b16 v[82:83], v116 offset:1024
    v_mfma_f32_32x32x16_bf16 v[36:51], v[92:95], v[88:91], v[36:51]
    v_mfma_f32_32x32x16_bf16 v[52:67], v[96:99], v[88:91], v[52:67]
    ds_read_b128 v[84:87], v112 offset:0
    ds_read_b128 v[88:91], v112 offset:4096
    ds_read_b64_tr_b16 v[92:93], v115 offset:4096
    ds_read_b64_tr_b16 v[94:95], v115 offset:5120
    ds_read_b64_tr_b16 v[96:97], v116 offset:4096
    ds_read_b64_tr_b16 v[98:99], v116 offset:5120
    s_waitcnt lgkmcnt(6)
    v_mfma_f32_32x32x16_bf16 v[4:19], v[76:79], v[68:71], v[4:19]
    s_mov_b32 s50, 0xc000
    s_add_u32 m0, s31, 0xc000
    s_nop 0
    buffer_load_dwordx4 v240, s[24:27], s50 offen lds
    v_mfma_f32_32x32x16_bf16 v[20:35], v[80:83], v[68:71], v[20:35]
    s_mov_b32 s50, 0xe000
    s_add_u32 m0, s31, 0xe000
    s_nop 0
    buffer_load_dwordx4 v240, s[24:27], s50 offen lds
    v_mfma_f32_32x32x16_bf16 v[36:51], v[76:79], v[72:75], v[36:51]
    s_mov_b32 s50, 0x0
    s_add_u32 m0, s31, 0x10000
    s_nop 0
    buffer_load_dwordx4 v240, s[12:15], s50 offen lds
    v_mfma_f32_32x32x16_bf16 v[52:67], v[80:83], v[72:75], v[52:67]
    s_mov_b32 s50, 0x2000
    s_add_u32 m0, s31, 0x12000
    s_nop 0
    buffer_load_dwordx4 v240, s[12:15], s50 offen lds
    ds_read_b128 v[68:71], v113 offset:0
    ds_read_b128 v[72:75], v113 offset:4096
    ds_read_b64_tr_b16 v[76:77], v115 offset:8192
    ds_read_b64_tr_b16 v[78:79], v115 offset:9216
    ds_read_b64_tr_b16 v[80:81], v116 offset:8192
    ds_read_b64_tr_b16 v[82:83], v116 offset:9216
    s_waitcnt lgkmcnt(6)
    v_mfma_f32_32x32x16_bf16 v[4:19], v[92:95], v[84:87], v[4:19]
    s_mov_b32 s50, 0x4000
    s_add_u32 m0, s31, 0x14000
    s_nop 0
    buffer_load_dwordx4 v240, s[12:15], s50 offen lds
    v_mfma_f32_32x32x16_bf16 v[20:35], v[96:99], v[84:87], v[20:35]
    s_mov_b32 s50, 0x6000
    s_add_u32 m0, s31, 0x16000
    s_nop 0
    buffer_load_dwordx4 v240, s[12:15], s50 offen lds
    v_mfma_f32_32x32x16_bf16 v[36:51], v[92:95], v[88:91], v[36:51]
    v_mfma_f32_32x32x16_bf16 v[52:67], v[96:99], v[88:91], v[52:67]
    ds_read_b128 v[84:87], v114 offset:0
    ds_read_b128 v[88:91], v114 offset:4096
    ds_read_b64_tr_b16 v[92:93], v115 offset:12288
    ds_read_b64_tr_b16 v[94:95], v115 offset:13312
    ds_read_b64_tr_b16 v[96:97], v116 offset:12288
    ds_read_b64_tr_b16 v[98:99], v116 offset:13312
    s_waitcnt lgkmcnt(6)
    v_mfma_f32_32x32x16_bf16 v[4:19], v[76:79], v[68:71], v[4:19]
    v_mfma_f32_32x32x16_bf16 v[20:35], v[80:83], v[68:71], v[20:35]
    v_mfma_f32_32x32x16_bf16 v[36:51], v[76:79], v[72:75], v[36:51]
    v_mfma_f32_32x32x16_bf16 v[52:67], v[80:83], v[72:75], v[52:67]
    s_waitcnt lgkmcnt(0)
    v_mfma_f32_32x32x16_bf16 v[4:19], v[92:95], v[84:87], v[4:19]
    v_mfma_f32_32x32x16_bf16 v[20:35], v[96:99], v[84:87], v[20:35]
    v_mfma_f32_32x32x16_bf16 v[36:51], v[92:95], v[88:91], v[36:51]
    v_mfma_f32_32x32x16_bf16 v[52:67], v[96:99], v[88:91], v[52:67]
    s_nop 15
    s_nop 3
    v_and_b32 v107, 31, v106
    v_lshrrev_b32 v108, 5, v106
    s_mul_i32 s37, s35, 64
    s_add_u32 s37, s37, s40
    s_mul_i32 s38, s36, 64
    s_add_u32 s38, s38, s42
    s_mov_b32 s39, 8192
    s_barrier
    s_mul_i32 s37, s35, 16384
    s_lshl_b32 s38, s36, 12
    s_add_u32 s37, s37, s38
    s_add_u32 s37, s37, 0x18000
    v_lshl_add_u32 v107, v106, 4, s37
    s_mov_b32 s38, 0x3e0293ee
    v_mul_f32 v4, s38, v4
    v_mul_f32 v5, s38, v5
    v_mul_f32 v6, s38, v6
    v_mul_f32 v7, s38, v7
    v_mul_f32 v8, s38, v8
    v_mul_f32 v9, s38, v9
    v_mul_f32 v10, s38, v10
    v_mul_f32 v11, s38, v11
    v_cvt_pk_bf16_f32 v68, v4, v5
    v_cvt_pk_bf16_f32 v69, v6, v7
    v_cvt_pk_bf16_f32 v70, v8, v9
    v_cvt_pk_bf16_f32 v71, v10, v11
    ds_write_b128 v107, v[68:71] offset:0
    v_mul_f32 v12, s38, v12
    v_mul_f32 v13, s38, v13
    v_mul_f32 v14, s38, v14
    v_mul_f32 v15, s38, v15
    v_mul_f32 v16, s38, v16
    v_mul_f32 v17, s38, v17
    v_mul_f32 v18, s38, v18
    v_mul_f32 v19, s38, v19
    v_cvt_pk_bf16_f32 v72, v12, v13
    v_cvt_pk_bf16_f32 v73, v14, v15
    v_cvt_pk_bf16_f32 v74, v16, v17
    v_cvt_pk_bf16_f32 v75, v18, v19
    ds_write_b128 v107, v[72:75] offset:1024
    v_mul_f32 v20, s38, v20
    v_mul_f32 v21, s38, v21
    v_mul_f32 v22, s38, v22
    v_mul_f32 v23, s38, v23
    v_mul_f32 v24, s38, v24
    v_mul_f32 v25, s38, v25
    v_mul_f32 v26, s38, v26
    v_mul_f32 v27, s38, v27
    v_cvt_pk_bf16_f32 v76, v20, v21
    v_cvt_pk_bf16_f32 v77, v22, v23
    v_cvt_pk_bf16_f32 v78, v24, v25
    v_cvt_pk_bf16_f32 v79, v26, v27
    ds_write_b128 v107, v[76:79] offset:2048
    v_mul_f32 v28, s38, v28
    v_mul_f32 v29, s38, v29
    v_mul_f32 v30, s38, v30
    v_mul_f32 v31, s38, v31
    v_mul_f32 v32, s38, v32
    v_mul_f32 v33, s38, v33
    v_mul_f32 v34, s38, v34
    v_mul_f32 v35, s38, v35
    v_cvt_pk_bf16_f32 v80, v28, v29
    v_cvt_pk_bf16_f32 v81, v30, v31
    v_cvt_pk_bf16_f32 v82, v32, v33
    v_cvt_pk_bf16_f32 v83, v34, v35
    ds_write_b128 v107, v[80:83] offset:3072
    v_mul_f32 v36, s38, v36
    v_mul_f32 v37, s38, v37
    v_mul_f32 v38, s38, v38
    v_mul_f32 v39, s38, v39
    v_mul_f32 v40, s38, v40
    v_mul_f32 v41, s38, v41
    v_mul_f32 v42, s38, v42
    v_mul_f32 v43, s38, v43
    v_cvt_pk_bf16_f32 v84, v36, v37
    v_cvt_pk_bf16_f32 v85, v38, v39
    v_cvt_pk_bf16_f32 v86, v40, v41
    v_cvt_pk_bf16_f32 v87, v42, v43
    ds_write_b128 v107, v[84:87] offset:8192
    v_mul_f32 v44, s38, v44
    v_mul_f32 v45, s38, v45
    v_mul_f32 v46, s38, v46
    v_mul_f32 v47, s38, v47
    v_mul_f32 v48, s38, v48
    v_mul_f32 v49, s38, v49
    v_mul_f32 v50, s38, v50
    v_mul_f32 v51, s38, v51
    v_cvt_pk_bf16_f32 v88, v44, v45
    v_cvt_pk_bf16_f32 v89, v46, v47
    v_cvt_pk_bf16_f32 v90, v48, v49
    v_cvt_pk_bf16_f32 v91, v50, v51
    ds_write_b128 v107, v[88:91] offset:9216
    v_mul_f32 v52, s38, v52
    v_mul_f32 v53, s38, v53
    v_mul_f32 v54, s38, v54
    v_mul_f32 v55, s38, v55
    v_mul_f32 v56, s38, v56
    v_mul_f32 v57, s38, v57
    v_mul_f32 v58, s38, v58
    v_mul_f32 v59, s38, v59
    v_cvt_pk_bf16_f32 v92, v52, v53
    v_cvt_pk_bf16_f32 v93, v54, v55
    v_cvt_pk_bf16_f32 v94, v56, v57
    v_cvt_pk_bf16_f32 v95, v58, v59
    ds_write_b128 v107, v[92:95] offset:10240
    v_mul_f32 v60, s38, v60
    v_mul_f32 v61, s38, v61
    v_mul_f32 v62, s38, v62
    v_mul_f32 v63, s38, v63
    v_mul_f32 v64, s38, v64
    v_mul_f32 v65, s38, v65
    v_mul_f32 v66, s38, v66
    v_mul_f32 v67, s38, v67
    v_cvt_pk_bf16_f32 v96, v60, v61
    v_cvt_pk_bf16_f32 v97, v62, v63
    v_cvt_pk_bf16_f32 v98, v64, v65
    v_cvt_pk_bf16_f32 v99, v66, v67
    ds_write_b128 v107, v[96:99] offset:11264
    s_lshl_b32 s31, s28, 10
    s_lshr_b32 s33, s28, 2
    s_and_b32 s34, s28, 3
    s_and_b32 s40, s2, 7
    s_lshl_b32 s40, s40, 2
    s_lshr_b32 s35, s2, 3
    s_and_b32 s35, s35, 3
    s_add_u32 s40, s40, s35
    s_lshr_b32 s48, s2, 5
    s_sub_u32 s41, 16, s48
    s_sub_u32 s43, 15, s48
    s_lshl_b32 s49, s43, 20
    s_lshl_b32 s47, s48, 20
    s_sub_u32 s39, s41, 2
    s_cmp_lt_u32 s28, 4
    s_cbranch_scc1 attn_kernel_np
    s_setprio 1
attn_kernel_np:
    s_mov_b32 s46, 0x3e0293ee
    s_mov_b32 s42, 0
    s_mov_b32 s44, 0x10000
    s_mov_b32 s50, 2
    s_mov_b32 s45, 0x8000
    s_mov_b32 s51, 1
    v_mov_b32 v4, 0
    v_mov_b32 v5, 0
    v_mov_b32 v6, 0
    v_mov_b32 v7, 0
    v_mov_b32 v8, 0
    v_mov_b32 v9, 0
    v_mov_b32 v10, 0
    v_mov_b32 v11, 0
    v_mov_b32 v12, 0
    v_mov_b32 v13, 0
    v_mov_b32 v14, 0
    v_mov_b32 v15, 0
    v_mov_b32 v16, 0
    v_mov_b32 v17, 0
    v_mov_b32 v18, 0
    v_mov_b32 v19, 0
    v_mov_b32 v20, 0
    v_mov_b32 v21, 0
    v_mov_b32 v22, 0
    v_mov_b32 v23, 0
    v_mov_b32 v24, 0
    v_mov_b32 v25, 0
    v_mov_b32 v26, 0
    v_mov_b32 v27, 0
    v_mov_b32 v28, 0
    v_mov_b32 v29, 0
    v_mov_b32 v30, 0
    v_mov_b32 v31, 0
    v_mov_b32 v32, 0
    v_mov_b32 v33, 0
    v_mov_b32 v34, 0
    v_mov_b32 v35, 0
    v_mov_b32 v36, 0
    v_mov_b32 v37, 0
    v_mov_b32 v38, 0
    v_mov_b32 v39, 0
    v_mov_b32 v40, 0
    v_mov_b32 v41, 0
    v_mov_b32 v42, 0
    v_mov_b32 v43, 0
    v_mov_b32 v44, 0
    v_mov_b32 v45, 0
    v_mov_b32 v46, 0
    v_mov_b32 v47, 0
    v_mov_b32 v48, 0
    v_mov_b32 v49, 0
    v_mov_b32 v50, 0
    v_mov_b32 v51, 0
    v_mov_b32 v52, 0
    v_mov_b32 v53, 0
    v_mov_b32 v54, 0
    v_mov_b32 v55, 0
    v_mov_b32 v56, 0
    v_mov_b32 v57, 0
    v_mov_b32 v58, 0
    v_mov_b32 v59, 0
    v_mov_b32 v60, 0
    v_mov_b32 v61, 0
    v_mov_b32 v62, 0
    v_mov_b32 v63, 0
    v_mov_b32 v64, 0
    v_mov_b32 v65, 0
    v_mov_b32 v66, 0
    v_mov_b32 v67, 0
    v_mov_b32 v232, 0xf149f2ca
    v_mov_b32 v233, 0
    v_mov_b32 v243, 0
    v_mov_b32 v247, 0
    s_mov_b32 s80, 1
    s_waitcnt vmcnt(8) lgkmcnt(0)
    s_barrier
    ds_read_b128 v[68:71], v229 offset:0
    ds_read_b128 v[72:75], v229 offset:1024
    ds_read_b128 v[76:79], v229 offset:2048
    ds_read_b128 v[80:83], v229 offset:3072
    ds_read_b128 v[84:87], v229 offset:4096
    ds_read_b128 v[88:91], v229 offset:5120
    ds_read_b128 v[92:95], v229 offset:6144
    ds_read_b128 v[96:99], v229 offset:7168
    ds_read_b128 v[180:183], v228 offset:0
    ds_read_b128 v[184:187], v228 offset:8192
    ds_read_b128 v[188:191], v228 offset:1024
    ds_read_b128 v[192:195], v228 offset:9216
    ds_read_b128 v[196:199], v228 offset:2048
    ds_read_b128 v[200:203], v228 offset:10240
    ds_read_b128 v[204:207], v228 offset:3072
    ds_read_b128 v[208:211], v228 offset:11264
    s_waitcnt lgkmcnt(7)
    v_mfma_f32_32x32x16_bf16 v[100:115], v[180:183], v[68:71], 0
    ds_read_b128 v[180:183], v228 offset:4096
    s_waitcnt lgkmcnt(7)
    v_mfma_f32_32x32x16_bf16 v[116:131], v[184:187], v[68:71], 0
    ds_read_b128 v[184:187], v228 offset:12288
    s_waitcnt lgkmcnt(7)
    v_mfma_f32_32x32x16_bf16 v[100:115], v[188:191], v[72:75], v[100:115]
    ds_read_b128 v[188:191], v228 offset:5120
    s_waitcnt lgkmcnt(7)
    v_mfma_f32_32x32x16_bf16 v[116:131], v[192:195], v[72:75], v[116:131]
    ds_read_b128 v[192:195], v228 offset:13312
    s_waitcnt lgkmcnt(7)
    v_mfma_f32_32x32x16_bf16 v[100:115], v[196:199], v[76:79], v[100:115]
    ds_read_b128 v[196:199], v228 offset:6144
    s_waitcnt lgkmcnt(7)
    v_mfma_f32_32x32x16_bf16 v[116:131], v[200:203], v[76:79], v[116:131]
    ds_read_b128 v[200:203], v228 offset:14336
    s_waitcnt lgkmcnt(7)
    v_mfma_f32_32x32x16_bf16 v[100:115], v[204:207], v[80:83], v[100:115]
    ds_read_b128 v[204:207], v228 offset:7168
    s_waitcnt lgkmcnt(7)
    v_mfma_f32_32x32x16_bf16 v[116:131], v[208:211], v[80:83], v[116:131]
    ds_read_b128 v[208:211], v228 offset:15360
    s_waitcnt vmcnt(0) lgkmcnt(0)
    s_barrier
    v_mfma_f32_32x32x16_bf16 v[100:115], v[180:183], v[84:87], v[100:115]
    ds_read_b128 v[180:183], v228 offset:32768
    s_add_u32 s36, s44, 0x0
    s_add_u32 m0, s31, 0x0
    s_nop 0
    buffer_load_dwordx4 v240, s[24:27], s36 offen lds
    s_waitcnt lgkmcnt(7)
    v_mfma_f32_32x32x16_bf16 v[116:131], v[184:187], v[84:87], v[116:131]
    ds_read_b128 v[184:187], v228 offset:40960
    s_add_u32 s36, s44, 0x2000
    s_add_u32 m0, s31, 0x2000
    s_nop 0
    buffer_load_dwordx4 v240, s[24:27], s36 offen lds
    s_waitcnt lgkmcnt(7)
    v_mfma_f32_32x32x16_bf16 v[100:115], v[188:191], v[88:91], v[100:115]
    ds_read_b128 v[188:191], v228 offset:33792
    s_add_u32 s36, s44, 0x4000
    s_add_u32 m0, s31, 0x4000
    s_nop 0
    buffer_load_dwordx4 v240, s[24:27], s36 offen lds
    s_waitcnt lgkmcnt(7)
    v_mfma_f32_32x32x16_bf16 v[116:131], v[192:195], v[88:91], v[116:131]
    ds_read_b128 v[192:195], v228 offset:41984
    s_add_u32 s36, s44, 0x6000
    s_add_u32 m0, s31, 0x6000
    s_nop 0
    buffer_load_dwordx4 v240, s[24:27], s36 offen lds
    s_add_u32 s44, s44, 0x8000
    s_add_u32 s50, s50, 1
    s_cmp_eq_u32 s50, s41
    s_cselect_b32 s44, 0, s44
    s_waitcnt lgkmcnt(7)
    v_mfma_f32_32x32x16_bf16 v[100:115], v[196:199], v[92:95], v[100:115]
    ds_read_b128 v[196:199], v228 offset:34816
    s_waitcnt lgkmcnt(7)
    v_mfma_f32_32x32x16_bf16 v[116:131], v[200:203], v[92:95], v[116:131]
    ds_read_b128 v[200:203], v228 offset:43008
    s_waitcnt lgkmcnt(7)
    v_mfma_f32_32x32x16_bf16 v[100:115], v[204:207], v[96:99], v[100:115]
    ds_read_b128 v[204:207], v228 offset:35840
    s_waitcnt lgkmcnt(7)
    v_mfma_f32_32x32x16_bf16 v[116:131], v[208:211], v[96:99], v[116:131]
    ds_read_b128 v[208:211], v228 offset:44032
    s_nop 7
    s_nop 7
attn_kernel_loop0:
    s_cmp_eq_u32 s42, s43
    s_cbranch_scc1 attn_kernel_last0
    v_max3_f32 v234, v100, v101, v102
    v_max3_f32 v235, v103, v104, v105
    v_max3_f32 v234, v234, v106, v107
    v_max3_f32 v235, v235, v108, v109
    v_max3_f32 v234, v234, v110, v111
    s_waitcnt lgkmcnt(7)
    v_mfma_f32_32x32x16_bf16 v[132:147], v[180:183], v[68:71], v[212:227]
    ds_read_b128 v[180:183], v228 offset:36864
    v_max3_f32 v235, v235, v112, v113
    v_max3_f32 v234, v234, v114, v115
    v_max3_f32 v235, v235, v116, v117
    v_max3_f32 v234, v234, v118, v119
    v_max3_f32 v235, v235, v120, v121
    s_waitcnt lgkmcnt(7)
    v_mfma_f32_32x32x16_bf16 v[148:163], v[184:187], v[68:71], v[212:227]
    ds_read_b128 v[184:187], v228 offset:45056
    v_max3_f32 v234, v234, v122, v123
    v_max3_f32 v235, v235, v124, v125
    v_max3_f32 v234, v234, v126, v127
    v_max3_f32 v235, v235, v128, v129
    v_max3_f32 v234, v234, v130, v131
    s_waitcnt lgkmcnt(7)
    v_mfma_f32_32x32x16_bf16 v[132:147], v[188:191], v[72:75], v[132:147]
    ds_read_b128 v[188:191], v228 offset:37888
    v_max_f32 v234, v234, v235
    v_mov_b32 v235, v234
    s_nop 1
    v_permlane32_swap_b32 v235, v234
    s_waitcnt lgkmcnt(7)
    v_mfma_f32_32x32x16_bf16 v[148:163], v[192:195], v[72:75], v[148:163]
    ds_read_b128 v[192:195], v228 offset:46080
    v_max_f32 v234, v234, v235
    v_cmp_lt_f32 vcc, 0x41000000, v234
    s_or_b32 s36, vcc_lo, s80
    s_or_b32 s36, s36, vcc_hi
    s_cbranch_scc0 attn_kernel_nr1
    v_add_f32 v235, v234, v247
    v_add_f32 v237, 0x41000000, v232
    v_cmp_gt_f32 vcc, v235, v237
    v_cndmask_b32 v236, v232, v235, vcc
    v_sub_f32 v237, v232, v236
    v_sub_f32 v235, v247, v236
    v_exp_f32 v237, v237
    s_mov_b32 s36, 0xf0000000
    v_cmp_lt_f32 s[52:53], s36, v232
    s_and_b64 s[52:53], s[52:53], vcc
    v_cmp_neq_f32 vcc, v231, v236
    v_mov_b32 v247, v231
    v_mov_b32 v231, v236
    v_mov_b32 v232, v236
    s_or_b32 s80, vcc_lo, vcc_hi
    v_add_f32 v100, v100, v235
    v_add_f32 v101, v101, v235
    v_add_f32 v102, v102, v235
    v_add_f32 v103, v103, v235
    v_add_f32 v104, v104, v235
    v_add_f32 v105, v105, v235
    v_add_f32 v106, v106, v235
    v_add_f32 v107, v107, v235
    v_add_f32 v108, v108, v235
    v_add_f32 v109, v109, v235
    v_add_f32 v110, v110, v235
    v_add_f32 v111, v111, v235
    v_add_f32 v112, v112, v235
    v_add_f32 v113, v113, v235
    v_add_f32 v114, v114, v235
    v_add_f32 v115, v115, v235
    v_add_f32 v116, v116, v235
    v_add_f32 v117, v117, v235
    v_add_f32 v118, v118, v235
    v_add_f32 v119, v119, v235
    v_add_f32 v120, v120, v235
    v_add_f32 v121, v121, v235
    v_add_f32 v122, v122, v235
    v_add_f32 v123, v123, v235
    v_add_f32 v124, v124, v235
    v_add_f32 v125, v125, v235
    v_add_f32 v126, v126, v235
    v_add_f32 v127, v127, v235
    v_add_f32 v128, v128, v235
    v_add_f32 v129, v129, v235
    v_add_f32 v130, v130, v235
    v_add_f32 v131, v131, v235
    s_cmp_eq_u32 s80, 0
    s_cbranch_scc1 attn_kernel_n12
    v_sub_f32 v212, 0, v236
    v_sub_f32 v213, 0, v236
    v_sub_f32 v214, 0, v236
    v_sub_f32 v215, 0, v236
    v_sub_f32 v216, 0, v236
    v_sub_f32 v217, 0, v236
    v_sub_f32 v218, 0, v236
    v_sub_f32 v219, 0, v236
    v_sub_f32 v220, 0, v236
    v_sub_f32 v221, 0, v236
    v_sub_f32 v222, 0, v236
    v_sub_f32 v223, 0, v236
    v_sub_f32 v224, 0, v236
    v_sub_f32 v225, 0, v236
    v_sub_f32 v226, 0, v236
    v_sub_f32 v227, 0, v236
    attn_kernel_n12:
    s_cmp_eq_u64 s[52:53], 0
    s_cbranch_scc1 attn_kernel_nr1
    v_mul_f32 v4, v4, v237
    v_mul_f32 v5, v5, v237
    v_mul_f32 v6, v6, v237
    v_mul_f32 v7, v7, v237
    v_mul_f32 v8, v8, v237
    v_mul_f32 v9, v9, v237
    v_mul_f32 v10, v10, v237
    v_mul_f32 v11, v11, v237
    v_mul_f32 v12, v12, v237
    v_mul_f32 v13, v13, v237
    v_mul_f32 v14, v14, v237
    v_mul_f32 v15, v15, v237
    v_mul_f32 v16, v16, v237
    v_mul_f32 v17, v17, v237
    v_mul_f32 v18, v18, v237
    v_mul_f32 v19, v19, v237
    v_mul_f32 v20, v20, v237
    v_mul_f32 v21, v21, v237
    v_mul_f32 v22, v22, v237
    v_mul_f32 v23, v23, v237
    v_mul_f32 v24, v24, v237
    v_mul_f32 v25, v25, v237
    v_mul_f32 v26, v26, v237
    v_mul_f32 v27, v27, v237
    v_mul_f32 v28, v28, v237
    v_mul_f32 v29, v29, v237
    v_mul_f32 v30, v30, v237
    v_mul_f32 v31, v31, v237
    v_mul_f32 v32, v32, v237
    v_mul_f32 v33, v33, v237
    v_mul_f32 v34, v34, v237
    v_mul_f32 v35, v35, v237
    v_mul_f32 v36, v36, v237
    v_mul_f32 v37, v37, v237
    v_mul_f32 v38, v38, v237
    v_mul_f32 v39, v39, v237
    v_mul_f32 v40, v40, v237
    v_mul_f32 v41, v41, v237
    v_mul_f32 v42, v42, v237
    v_mul_f32 v43, v43, v237
    v_mul_f32 v44, v44, v237
    v_mul_f32 v45, v45, v237
    v_mul_f32 v46, v46, v237
    v_mul_f32 v47, v47, v237
    v_mul_f32 v48, v48, v237
    v_mul_f32 v49, v49, v237
    v_mul_f32 v50, v50, v237
    v_mul_f32 v51, v51, v237
    v_mul_f32 v52, v52, v237
    v_mul_f32 v53, v53, v237
    v_mul_f32 v54, v54, v237
    v_mul_f32 v55, v55, v237
    v_mul_f32 v56, v56, v237
    v_mul_f32 v57, v57, v237
    v_mul_f32 v58, v58, v237
    v_mul_f32 v59, v59, v237
    v_mul_f32 v60, v60, v237
    v_mul_f32 v61, v61, v237
    v_mul_f32 v62, v62, v237
    v_mul_f32 v63, v63, v237
    v_mul_f32 v64, v64, v237
    v_mul_f32 v65, v65, v237
    v_mul_f32 v66, v66, v237
    v_mul_f32 v67, v67, v237
    v_mul_f32 v233, v233, v237
    v_mul_f32 v243, v243, v237
attn_kernel_nr1:
    v_exp_f32 v100, v100
    s_waitcnt lgkmcnt(7)
    v_mfma_f32_32x32x16_bf16 v[132:147], v[196:199], v[76:79], v[132:147]
    ds_read_b128 v[196:199], v228 offset:38912
    v_exp_f32 v101, v101
    v_exp_f32 v102, v102
    s_waitcnt lgkmcnt(7)
    v_mfma_f32_32x32x16_bf16 v[148:163], v[200:203], v[76:79], v[148:163]
    ds_read_b128 v[200:203], v228 offset:47104
    v_exp_f32 v103, v103
    s_waitcnt lgkmcnt(7)
    v_mfma_f32_32x32x16_bf16 v[132:147], v[204:207], v[80:83], v[132:147]
    ds_read_b128 v[204:207], v228 offset:39936
    v_exp_f32 v104, v104
    v_exp_f32 v105, v105
    s_waitcnt lgkmcnt(7)
    v_mfma_f32_32x32x16_bf16 v[148:163], v[208:211], v[80:83], v[148:163]
    ds_read_b128 v[208:211], v228 offset:48128
    v_exp_f32 v106, v106
    v_exp_f32 v107, v107
    v_cvt_pk_bf16_f32 v164, v100, v101
    v_cvt_pk_bf16_f32 v165, v102, v103
    s_waitcnt vmcnt(5) lgkmcnt(0)
    s_cmp_eq_u32 s42, 16
    s_cbranch_scc1 attn_kernel_g13
    s_waitcnt vmcnt(0)
attn_kernel_g13:
    s_barrier
    v_mfma_f32_32x32x16_bf16 v[132:147], v[180:183], v[84:87], v[132:147]
    ds_read_b128 v[180:183], v230 offset:0
    s_cmp_ge_u32 s51, 17
    s_cbranch_scc1 attn_kernel_dv3
    s_add_u32 s36, s45, 0x0
    s_add_u32 m0, s31, 0x18000
    s_nop 0
    buffer_load_dwordx4 v240, s[12:15], s36 offen lds
attn_kernel_dv3:
    v_cvt_pk_bf16_f32 v166, v104, v105
    v_cvt_pk_bf16_f32 v167, v106, v107
    v_add_f32 v233, v233, v100
    v_add_f32 v243, v243, v101
    s_waitcnt lgkmcnt(7)
    v_mfma_f32_32x32x16_bf16 v[148:163], v[184:187], v[84:87], v[148:163]
    ds_read_b128 v[184:187], v230 offset:8192
    v_add_f32 v233, v233, v102
    v_add_f32 v243, v243, v103
    v_add_f32 v233, v233, v104
    v_add_f32 v243, v243, v105
    v_add_f32 v233, v233, v106
    s_waitcnt lgkmcnt(7)
    v_mfma_f32_32x32x16_bf16 v[132:147], v[188:191], v[88:91], v[132:147]
    ds_read_b128 v[188:191], v230 offset:16384
    s_cmp_ge_u32 s51, 17
    s_cbranch_scc1 attn_kernel_dv4
    s_add_u32 s36, s45, 0x2000
    s_add_u32 m0, s31, 0x1a000
    s_nop 0
    buffer_load_dwordx4 v240, s[12:15], s36 offen lds
attn_kernel_dv4:
    v_add_f32 v243, v243, v107
    v_exp_f32 v108, v108
    s_waitcnt lgkmcnt(7)
    v_mfma_f32_32x32x16_bf16 v[148:163], v[192:195], v[88:91], v[148:163]
    ds_read_b128 v[192:195], v230 offset:24576
    v_exp_f32 v109, v109
    v_exp_f32 v110, v110
    s_waitcnt lgkmcnt(7)
    v_mfma_f32_32x32x16_bf16 v[132:147], v[196:199], v[92:95], v[132:147]
    ds_read_b128 v[196:199], v230 offset:1024
    s_cmp_ge_u32 s51, 17
    s_cbranch_scc1 attn_kernel_dv5
    s_add_u32 s36, s45, 0x4000
    s_add_u32 m0, s31, 0x1c000
    s_nop 0
    buffer_load_dwordx4 v240, s[12:15], s36 offen lds
attn_kernel_dv5:
    v_exp_f32 v111, v111
    v_exp_f32 v112, v112
    s_waitcnt lgkmcnt(7)
    v_mfma_f32_32x32x16_bf16 v[148:163], v[200:203], v[92:95], v[148:163]
    ds_read_b128 v[200:203], v230 offset:9216
    v_exp_f32 v113, v113
    v_exp_f32 v114, v114
    s_waitcnt lgkmcnt(7)
    v_mfma_f32_32x32x16_bf16 v[132:147], v[204:207], v[96:99], v[132:147]
    ds_read_b128 v[204:207], v230 offset:17408
    s_cmp_ge_u32 s51, 17
    s_cbranch_scc1 attn_kernel_dv6
    s_add_u32 s36, s45, 0x6000
    s_add_u32 m0, s31, 0x1e000
    s_nop 0
    buffer_load_dwordx4 v240, s[12:15], s36 offen lds
    s_add_u32 s45, s45, 0x8000
    s_add_u32 s51, s51, 1
    s_cmp_eq_u32 s51, s41
    s_cselect_b32 s45, 0, s45
attn_kernel_dv6:
    v_exp_f32 v115, v115
    v_cvt_pk_bf16_f32 v168, v108, v109
    v_cvt_pk_bf16_f32 v169, v110, v111
    v_cvt_pk_bf16_f32 v170, v112, v113
    s_waitcnt lgkmcnt(7)
    v_mfma_f32_32x32x16_bf16 v[148:163], v[208:211], v[96:99], v[148:163]
    ds_read_b128 v[208:211], v230 offset:25600
    v_cvt_pk_bf16_f32 v171, v114, v115
    v_add_f32 v233, v233, v108
    v_add_f32 v243, v243, v109
    v_add_f32 v233, v233, v110
    v_add_f32 v243, v243, v111
    s_nop 1
    s_waitcnt lgkmcnt(7)
    v_mfma_f32_32x32x16_bf16 v[4:19], v[180:183], v[164:167], v[4:19]
    ds_read_b128 v[180:183], v230 offset:2048
    s_cmp_ge_u32 s50, 17
    s_cbranch_scc1 attn_kernel_dk7
    s_add_u32 s36, s44, 0x0
    s_add_u32 m0, s31, 0x8000
    s_nop 0
    buffer_load_dwordx4 v240, s[24:27], s36 offen lds
attn_kernel_dk7:
    v_add_f32 v233, v233, v112
    v_add_f32 v243, v243, v113
    v_add_f32 v233, v233, v114
    v_add_f32 v243, v243, v115
    s_waitcnt lgkmcnt(7)
    v_mfma_f32_32x32x16_bf16 v[20:35], v[184:187], v[164:167], v[20:35]
    ds_read_b128 v[184:187], v230 offset:10240
    v_exp_f32 v116, v116
    v_exp_f32 v117, v117
    s_waitcnt lgkmcnt(7)
    v_mfma_f32_32x32x16_bf16 v[36:51], v[188:191], v[164:167], v[36:51]
    ds_read_b128 v[188:191], v230 offset:18432
    s_cmp_ge_u32 s50, 17
    s_cbranch_scc1 attn_kernel_dk8
    s_add_u32 s36, s44, 0x2000
    s_add_u32 m0, s31, 0xa000
    s_nop 0
    buffer_load_dwordx4 v240, s[24:27], s36 offen lds
attn_kernel_dk8:
    v_exp_f32 v118, v118
    v_exp_f32 v119, v119
    s_waitcnt lgkmcnt(7)
    v_mfma_f32_32x32x16_bf16 v[52:67], v[192:195], v[164:167], v[52:67]
    ds_read_b128 v[192:195], v230 offset:26624
    s_cmp_lg_u32 s42, s39
    s_cbranch_scc1 attn_kernel_ql11
    ds_read_b128 v[68:71], v229 offset:32768
    ds_read_b128 v[72:75], v229 offset:33792
    ds_read_b128 v[76:79], v229 offset:34816
    ds_read_b128 v[80:83], v229 offset:35840
    ds_read_b128 v[84:87], v229 offset:36864
    ds_read_b128 v[88:91], v229 offset:37888
    ds_read_b128 v[92:95], v229 offset:38912
    ds_read_b128 v[96:99], v229 offset:39936
attn_kernel_ql11:
    v_exp_f32 v120, v120
    v_exp_f32 v121, v121
    s_nop 1
    s_waitcnt lgkmcnt(7)
    v_mfma_f32_32x32x16_bf16 v[4:19], v[196:199], v[168:171], v[4:19]
    ds_read_b128 v[196:199], v230 offset:3072
    s_cmp_ge_u32 s50, 17
    s_cbranch_scc1 attn_kernel_dk9
    s_add_u32 s36, s44, 0x4000
    s_add_u32 m0, s31, 0xc000
    s_nop 0
    buffer_load_dwordx4 v240, s[24:27], s36 offen lds
attn_kernel_dk9:
    v_exp_f32 v122, v122
    v_exp_f32 v123, v123
    s_waitcnt lgkmcnt(7)
    v_mfma_f32_32x32x16_bf16 v[20:35], v[200:203], v[168:171], v[20:35]
    ds_read_b128 v[200:203], v230 offset:11264
    v_cvt_pk_bf16_f32 v172, v116, v117
    v_cvt_pk_bf16_f32 v173, v118, v119
    v_cvt_pk_bf16_f32 v174, v120, v121
    v_cvt_pk_bf16_f32 v175, v122, v123
    v_add_f32 v233, v233, v116
    s_waitcnt lgkmcnt(7)
    v_mfma_f32_32x32x16_bf16 v[36:51], v[204:207], v[168:171], v[36:51]
    ds_read_b128 v[204:207], v230 offset:19456
    s_cmp_ge_u32 s50, 17
    s_cbranch_scc1 attn_kernel_dk10
    s_add_u32 s36, s44, 0x6000
    s_add_u32 m0, s31, 0xe000
    s_nop 0
    buffer_load_dwordx4 v240, s[24:27], s36 offen lds
    s_add_u32 s44, s44, 0x8000
    s_add_u32 s50, s50, 1
    s_cmp_eq_u32 s50, s41
    s_cselect_b32 s44, 0, s44
attn_kernel_dk10:
    v_add_f32 v243, v243, v117
    v_add_f32 v233, v233, v118
    v_add_f32 v243, v243, v119
    v_add_f32 v233, v233, v120
    v_add_f32 v243, v243, v121
    s_waitcnt lgkmcnt(7)
    v_mfma_f32_32x32x16_bf16 v[52:67], v[208:211], v[168:171], v[52:67]
    ds_read_b128 v[208:211], v230 offset:27648
    s_cmp_lg_u32 s42, 15
    s_cbranch_scc1 attn_kernel_wp12
    v_lshlrev_b32 v244, 4, v0
    buffer_load_dwordx4 v[248:251], v244, s[60:63], 0 offen
    buffer_load_dwordx4 v[248:251], v244, s[64:67], 0 offen
    buffer_load_dwordx4 v[248:251], v244, s[68:71], 0 offen
    buffer_load_dwordx4 v[248:251], v244, s[72:75], 0 offen
    buffer_load_dwordx4 v[248:251], v244, s[76:79], 0 offen
attn_kernel_wp12:
    v_add_f32 v233, v233, v122
    v_add_f32 v243, v243, v123
    v_exp_f32 v124, v124
    s_nop 1
    s_waitcnt lgkmcnt(7)
    v_mfma_f32_32x32x16_bf16 v[4:19], v[180:183], v[172:175], v[4:19]
    ds_read_b128 v[180:183], v228 offset:0
    v_exp_f32 v125, v125
    v_exp_f32 v126, v126
    v_exp_f32 v127, v127
    s_waitcnt lgkmcnt(7)
    v_mfma_f32_32x32x16_bf16 v[20:35], v[184:187], v[172:175], v[20:35]
    ds_read_b128 v[184:187], v228 offset:8192
    v_exp_f32 v128, v128
    v_exp_f32 v129, v129
    v_exp_f32 v130, v130
    s_waitcnt lgkmcnt(7)
    v_mfma_f32_32x32x16_bf16 v[36:51], v[188:191], v[172:175], v[36:51]
    ds_read_b128 v[188:191], v228 offset:1024
    v_exp_f32 v131, v131
    v_cvt_pk_bf16_f32 v176, v124, v125
    v_cvt_pk_bf16_f32 v177, v126, v127
    s_waitcnt lgkmcnt(7)
    v_mfma_f32_32x32x16_bf16 v[52:67], v[192:195], v[172:175], v[52:67]
    ds_read_b128 v[192:195], v228 offset:9216
    v_cvt_pk_bf16_f32 v178, v128, v129
    v_cvt_pk_bf16_f32 v179, v130, v131
    s_nop 1
    s_waitcnt lgkmcnt(7)
    v_mfma_f32_32x32x16_bf16 v[4:19], v[196:199], v[176:179], v[4:19]
    ds_read_b128 v[196:199], v228 offset:2048
    v_add_f32 v233, v233, v124
    v_add_f32 v243, v243, v125
    v_add_f32 v233, v233, v126
    s_waitcnt lgkmcnt(7)
    v_mfma_f32_32x32x16_bf16 v[20:35], v[200:203], v[176:179], v[20:35]
    ds_read_b128 v[200:203], v228 offset:10240
    v_add_f32 v243, v243, v127
    v_add_f32 v233, v233, v128
    v_add_f32 v243, v243, v129
    v_add_f32 v233, v233, v130
    v_add_f32 v243, v243, v131
    s_waitcnt lgkmcnt(7)
    v_mfma_f32_32x32x16_bf16 v[36:51], v[204:207], v[176:179], v[36:51]
    ds_read_b128 v[204:207], v228 offset:3072
    s_waitcnt lgkmcnt(7)
    v_mfma_f32_32x32x16_bf16 v[52:67], v[208:211], v[176:179], v[52:67]
    ds_read_b128 v[208:211], v228 offset:11264
    s_add_u32 s42, s42, 1
attn_kernel_loop1:
    s_cmp_eq_u32 s42, s43
    s_cbranch_scc1 attn_kernel_last1
    v_max3_f32 v234, v132, v133, v134
    v_max3_f32 v235, v135, v136, v137
    v_max3_f32 v234, v234, v138, v139
    v_max3_f32 v235, v235, v140, v141
    v_max3_f32 v234, v234, v142, v143
    s_waitcnt lgkmcnt(7)
    v_mfma_f32_32x32x16_bf16 v[100:115], v[180:183], v[68:71], v[212:227]
    ds_read_b128 v[180:183], v228 offset:4096
    v_max3_f32 v235, v235, v144, v145
    v_max3_f32 v234, v234, v146, v147
    v_max3_f32 v235, v235, v148, v149
    v_max3_f32 v234, v234, v150, v151
    v_max3_f32 v235, v235, v152, v153
    s_waitcnt lgkmcnt(7)
    v_mfma_f32_32x32x16_bf16 v[116:131], v[184:187], v[68:71], v[212:227]
    ds_read_b128 v[184:187], v228 offset:12288
    v_max3_f32 v234, v234, v154, v155
    v_max3_f32 v235, v235, v156, v157
    v_max3_f32 v234, v234, v158, v159
    v_max3_f32 v235, v235, v160, v161
    v_max3_f32 v234, v234, v162, v163
    s_waitcnt lgkmcnt(7)
    v_mfma_f32_32x32x16_bf16 v[100:115], v[188:191], v[72:75], v[100:115]
    ds_read_b128 v[188:191], v228 offset:5120
    v_max_f32 v234, v234, v235
    v_mov_b32 v235, v234
    s_nop 1
    v_permlane32_swap_b32 v235, v234
    s_waitcnt lgkmcnt(7)
    v_mfma_f32_32x32x16_bf16 v[116:131], v[192:195], v[72:75], v[116:131]
    ds_read_b128 v[192:195], v228 offset:13312
    v_max_f32 v234, v234, v235
    v_cmp_lt_f32 vcc, 0x41000000, v234
    s_or_b32 s36, vcc_lo, s80
    s_or_b32 s36, s36, vcc_hi
    s_cbranch_scc0 attn_kernel_nr14
    v_add_f32 v235, v234, v247
    v_add_f32 v237, 0x41000000, v232
    v_cmp_gt_f32 vcc, v235, v237
    v_cndmask_b32 v236, v232, v235, vcc
    v_sub_f32 v237, v232, v236
    v_sub_f32 v235, v247, v236
    v_exp_f32 v237, v237
    s_mov_b32 s36, 0xf0000000
    v_cmp_lt_f32 s[52:53], s36, v232
    s_and_b64 s[52:53], s[52:53], vcc
    v_cmp_neq_f32 vcc, v231, v236
    v_mov_b32 v247, v231
    v_mov_b32 v231, v236
    v_mov_b32 v232, v236
    s_or_b32 s80, vcc_lo, vcc_hi
    v_add_f32 v132, v132, v235
    v_add_f32 v133, v133, v235
    v_add_f32 v134, v134, v235
    v_add_f32 v135, v135, v235
    v_add_f32 v136, v136, v235
    v_add_f32 v137, v137, v235
    v_add_f32 v138, v138, v235
    v_add_f32 v139, v139, v235
    v_add_f32 v140, v140, v235
    v_add_f32 v141, v141, v235
    v_add_f32 v142, v142, v235
    v_add_f32 v143, v143, v235
    v_add_f32 v144, v144, v235
    v_add_f32 v145, v145, v235
    v_add_f32 v146, v146, v235
    v_add_f32 v147, v147, v235
    v_add_f32 v148, v148, v235
    v_add_f32 v149, v149, v235
    v_add_f32 v150, v150, v235
    v_add_f32 v151, v151, v235
    v_add_f32 v152, v152, v235
    v_add_f32 v153, v153, v235
    v_add_f32 v154, v154, v235
    v_add_f32 v155, v155, v235
    v_add_f32 v156, v156, v235
    v_add_f32 v157, v157, v235
    v_add_f32 v158, v158, v235
    v_add_f32 v159, v159, v235
    v_add_f32 v160, v160, v235
    v_add_f32 v161, v161, v235
    v_add_f32 v162, v162, v235
    v_add_f32 v163, v163, v235
    s_cmp_eq_u32 s80, 0
    s_cbranch_scc1 attn_kernel_n115
    v_sub_f32 v212, 0, v236
    v_sub_f32 v213, 0, v236
    v_sub_f32 v214, 0, v236
    v_sub_f32 v215, 0, v236
    v_sub_f32 v216, 0, v236
    v_sub_f32 v217, 0, v236
    v_sub_f32 v218, 0, v236
    v_sub_f32 v219, 0, v236
    v_sub_f32 v220, 0, v236
    v_sub_f32 v221, 0, v236
    v_sub_f32 v222, 0, v236
    v_sub_f32 v223, 0, v236
    v_sub_f32 v224, 0, v236
    v_sub_f32 v225, 0, v236
    v_sub_f32 v226, 0, v236
    v_sub_f32 v227, 0, v236
    attn_kernel_n115:
    s_cmp_eq_u64 s[52:53], 0
    s_cbranch_scc1 attn_kernel_nr14
    v_mul_f32 v4, v4, v237
    v_mul_f32 v5, v5, v237
    v_mul_f32 v6, v6, v237
    v_mul_f32 v7, v7, v237
    v_mul_f32 v8, v8, v237
    v_mul_f32 v9, v9, v237
    v_mul_f32 v10, v10, v237
    v_mul_f32 v11, v11, v237
    v_mul_f32 v12, v12, v237
    v_mul_f32 v13, v13, v237
    v_mul_f32 v14, v14, v237
    v_mul_f32 v15, v15, v237
    v_mul_f32 v16, v16, v237
    v_mul_f32 v17, v17, v237
    v_mul_f32 v18, v18, v237
    v_mul_f32 v19, v19, v237
    v_mul_f32 v20, v20, v237
    v_mul_f32 v21, v21, v237
    v_mul_f32 v22, v22, v237
    v_mul_f32 v23, v23, v237
    v_mul_f32 v24, v24, v237
    v_mul_f32 v25, v25, v237
    v_mul_f32 v26, v26, v237
    v_mul_f32 v27, v27, v237
    v_mul_f32 v28, v28, v237
    v_mul_f32 v29, v29, v237
    v_mul_f32 v30, v30, v237
    v_mul_f32 v31, v31, v237
    v_mul_f32 v32, v32, v237
    v_mul_f32 v33, v33, v237
    v_mul_f32 v34, v34, v237
    v_mul_f32 v35, v35, v237
    v_mul_f32 v36, v36, v237
    v_mul_f32 v37, v37, v237
    v_mul_f32 v38, v38, v237
    v_mul_f32 v39, v39, v237
    v_mul_f32 v40, v40, v237
    v_mul_f32 v41, v41, v237
    v_mul_f32 v42, v42, v237
    v_mul_f32 v43, v43, v237
    v_mul_f32 v44, v44, v237
    v_mul_f32 v45, v45, v237
    v_mul_f32 v46, v46, v237
    v_mul_f32 v47, v47, v237
    v_mul_f32 v48, v48, v237
    v_mul_f32 v49, v49, v237
    v_mul_f32 v50, v50, v237
    v_mul_f32 v51, v51, v237
    v_mul_f32 v52, v52, v237
    v_mul_f32 v53, v53, v237
    v_mul_f32 v54, v54, v237
    v_mul_f32 v55, v55, v237
    v_mul_f32 v56, v56, v237
    v_mul_f32 v57, v57, v237
    v_mul_f32 v58, v58, v237
    v_mul_f32 v59, v59, v237
    v_mul_f32 v60, v60, v237
    v_mul_f32 v61, v61, v237
    v_mul_f32 v62, v62, v237
    v_mul_f32 v63, v63, v237
    v_mul_f32 v64, v64, v237
    v_mul_f32 v65, v65, v237
    v_mul_f32 v66, v66, v237
    v_mul_f32 v67, v67, v237
    v_mul_f32 v233, v233, v237
    v_mul_f32 v243, v243, v237
attn_kernel_nr14:
    v_exp_f32 v132, v132
    s_waitcnt lgkmcnt(7)
    v_mfma_f32_32x32x16_bf16 v[100:115], v[196:199], v[76:79], v[100:115]
    ds_read_b128 v[196:199], v228 offset:6144
    v_exp_f32 v133, v133
    v_exp_f32 v134, v134
    s_waitcnt lgkmcnt(7)
    v_mfma_f32_32x32x16_bf16 v[116:131], v[200:203], v[76:79], v[116:131]
    ds_read_b128 v[200:203], v228 offset:14336
    v_exp_f32 v135, v135
    s_waitcnt lgkmcnt(7)
    v_mfma_f32_32x32x16_bf16 v[100:115], v[204:207], v[80:83], v[100:115]
    ds_read_b128 v[204:207], v228 offset:7168
    v_exp_f32 v136, v136
    v_exp_f32 v137, v137
    s_waitcnt lgkmcnt(7)
    v_mfma_f32_32x32x16_bf16 v[116:131], v[208:211], v[80:83], v[116:131]
    ds_read_b128 v[208:211], v228 offset:15360
    v_exp_f32 v138, v138
    v_exp_f32 v139, v139
    v_cvt_pk_bf16_f32 v164, v132, v133
    v_cvt_pk_bf16_f32 v165, v134, v135
    s_waitcnt vmcnt(5) lgkmcnt(0)
    s_cmp_eq_u32 s42, 16
    s_cbranch_scc1 attn_kernel_g26
    s_waitcnt vmcnt(0)
attn_kernel_g26:
    s_barrier
    v_mfma_f32_32x32x16_bf16 v[100:115], v[180:183], v[84:87], v[100:115]
    ds_read_b128 v[180:183], v230 offset:32768
    s_cmp_ge_u32 s51, 17
    s_cbranch_scc1 attn_kernel_dv16
    s_add_u32 s36, s45, 0x0
    s_add_u32 m0, s31, 0x10000
    s_nop 0
    buffer_load_dwordx4 v240, s[12:15], s36 offen lds
attn_kernel_dv16:
    v_cvt_pk_bf16_f32 v166, v136, v137
    v_cvt_pk_bf16_f32 v167, v138, v139
    v_add_f32 v233, v233, v132
    v_add_f32 v243, v243, v133
    s_waitcnt lgkmcnt(7)
    v_mfma_f32_32x32x16_bf16 v[116:131], v[184:187], v[84:87], v[116:131]
    ds_read_b128 v[184:187], v230 offset:40960
    v_add_f32 v233, v233, v134
    v_add_f32 v243, v243, v135
    v_add_f32 v233, v233, v136
    v_add_f32 v243, v243, v137
    v_add_f32 v233, v233, v138
    s_waitcnt lgkmcnt(7)
    v_mfma_f32_32x32x16_bf16 v[100:115], v[188:191], v[88:91], v[100:115]
    ds_read_b128 v[188:191], v230 offset:49152
    s_cmp_ge_u32 s51, 17
    s_cbranch_scc1 attn_kernel_dv17
    s_add_u32 s36, s45, 0x2000
    s_add_u32 m0, s31, 0x12000
    s_nop 0
    buffer_load_dwordx4 v240, s[12:15], s36 offen lds
attn_kernel_dv17:
    v_add_f32 v243, v243, v139
    v_exp_f32 v140, v140
    s_waitcnt lgkmcnt(7)
    v_mfma_f32_32x32x16_bf16 v[116:131], v[192:195], v[88:91], v[116:131]
    ds_read_b128 v[192:195], v230 offset:57344
    v_exp_f32 v141, v141
    v_exp_f32 v142, v142
    s_waitcnt lgkmcnt(7)
    v_mfma_f32_32x32x16_bf16 v[100:115], v[196:199], v[92:95], v[100:115]
    ds_read_b128 v[196:199], v230 offset:33792
    s_cmp_ge_u32 s51, 17
    s_cbranch_scc1 attn_kernel_dv18
    s_add_u32 s36, s45, 0x4000
    s_add_u32 m0, s31, 0x14000
    s_nop 0
    buffer_load_dwordx4 v240, s[12:15], s36 offen lds
attn_kernel_dv18:
    v_exp_f32 v143, v143
    v_exp_f32 v144, v144
    s_waitcnt lgkmcnt(7)
    v_mfma_f32_32x32x16_bf16 v[116:131], v[200:203], v[92:95], v[116:131]
    ds_read_b128 v[200:203], v230 offset:41984
    v_exp_f32 v145, v145
    v_exp_f32 v146, v146
    s_waitcnt lgkmcnt(7)
    v_mfma_f32_32x32x16_bf16 v[100:115], v[204:207], v[96:99], v[100:115]
    ds_read_b128 v[204:207], v230 offset:50176
    s_cmp_ge_u32 s51, 17
    s_cbranch_scc1 attn_kernel_dv19
    s_add_u32 s36, s45, 0x6000
    s_add_u32 m0, s31, 0x16000
    s_nop 0
    buffer_load_dwordx4 v240, s[12:15], s36 offen lds
    s_add_u32 s45, s45, 0x8000
    s_add_u32 s51, s51, 1
    s_cmp_eq_u32 s51, s41
    s_cselect_b32 s45, 0, s45
attn_kernel_dv19:
    v_exp_f32 v147, v147
    v_cvt_pk_bf16_f32 v168, v140, v141
    v_cvt_pk_bf16_f32 v169, v142, v143
    v_cvt_pk_bf16_f32 v170, v144, v145
    s_waitcnt lgkmcnt(7)
    v_mfma_f32_32x32x16_bf16 v[116:131], v[208:211], v[96:99], v[116:131]
    ds_read_b128 v[208:211], v230 offset:58368
    v_cvt_pk_bf16_f32 v171, v146, v147
    v_add_f32 v233, v233, v140
    v_add_f32 v243, v243, v141
    v_add_f32 v233, v233, v142
    v_add_f32 v243, v243, v143
    s_nop 1
    s_waitcnt lgkmcnt(7)
    v_mfma_f32_32x32x16_bf16 v[4:19], v[180:183], v[164:167], v[4:19]
    ds_read_b128 v[180:183], v230 offset:34816
    s_cmp_ge_u32 s50, 17
    s_cbranch_scc1 attn_kernel_dk20
    s_add_u32 s36, s44, 0x0
    s_add_u32 m0, s31, 0x0
    s_nop 0
    buffer_load_dwordx4 v240, s[24:27], s36 offen lds
attn_kernel_dk20:
    v_add_f32 v233, v233, v144
    v_add_f32 v243, v243, v145
    v_add_f32 v233, v233, v146
    v_add_f32 v243, v243, v147
    s_waitcnt lgkmcnt(7)
    v_mfma_f32_32x32x16_bf16 v[20:35], v[184:187], v[164:167], v[20:35]
    ds_read_b128 v[184:187], v230 offset:43008
    v_exp_f32 v148, v148
    v_exp_f32 v149, v149
    s_waitcnt lgkmcnt(7)
    v_mfma_f32_32x32x16_bf16 v[36:51], v[188:191], v[164:167], v[36:51]
    ds_read_b128 v[188:191], v230 offset:51200
    s_cmp_ge_u32 s50, 17
    s_cbranch_scc1 attn_kernel_dk21
    s_add_u32 s36, s44, 0x2000
    s_add_u32 m0, s31, 0x2000
    s_nop 0
    buffer_load_dwordx4 v240, s[24:27], s36 offen lds
attn_kernel_dk21:
    v_exp_f32 v150, v150
    v_exp_f32 v151, v151
    s_waitcnt lgkmcnt(7)
    v_mfma_f32_32x32x16_bf16 v[52:67], v[192:195], v[164:167], v[52:67]
    ds_read_b128 v[192:195], v230 offset:59392
    s_cmp_lg_u32 s42, s39
    s_cbranch_scc1 attn_kernel_ql24
    ds_read_b128 v[68:71], v229 offset:32768
    ds_read_b128 v[72:75], v229 offset:33792
    ds_read_b128 v[76:79], v229 offset:34816
    ds_read_b128 v[80:83], v229 offset:35840
    ds_read_b128 v[84:87], v229 offset:36864
    ds_read_b128 v[88:91], v229 offset:37888
    ds_read_b128 v[92:95], v229 offset:38912
    ds_read_b128 v[96:99], v229 offset:39936
attn_kernel_ql24:
    v_exp_f32 v152, v152
    v_exp_f32 v153, v153
    s_nop 1
    s_waitcnt lgkmcnt(7)
    v_mfma_f32_32x32x16_bf16 v[4:19], v[196:199], v[168:171], v[4:19]
    ds_read_b128 v[196:199], v230 offset:35840
    s_cmp_ge_u32 s50, 17
    s_cbranch_scc1 attn_kernel_dk22
    s_add_u32 s36, s44, 0x4000
    s_add_u32 m0, s31, 0x4000
    s_nop 0
    buffer_load_dwordx4 v240, s[24:27], s36 offen lds
attn_kernel_dk22:
    v_exp_f32 v154, v154
    v_exp_f32 v155, v155
    s_waitcnt lgkmcnt(7)
    v_mfma_f32_32x32x16_bf16 v[20:35], v[200:203], v[168:171], v[20:35]
    ds_read_b128 v[200:203], v230 offset:44032
    v_cvt_pk_bf16_f32 v172, v148, v149
    v_cvt_pk_bf16_f32 v173, v150, v151
    v_cvt_pk_bf16_f32 v174, v152, v153
    v_cvt_pk_bf16_f32 v175, v154, v155
    v_add_f32 v233, v233, v148
    s_waitcnt lgkmcnt(7)
    v_mfma_f32_32x32x16_bf16 v[36:51], v[204:207], v[168:171], v[36:51]
    ds_read_b128 v[204:207], v230 offset:52224
    s_cmp_ge_u32 s50, 17
    s_cbranch_scc1 attn_kernel_dk23
    s_add_u32 s36, s44, 0x6000
    s_add_u32 m0, s31, 0x6000
    s_nop 0
    buffer_load_dwordx4 v240, s[24:27], s36 offen lds
    s_add_u32 s44, s44, 0x8000
    s_add_u32 s50, s50, 1
    s_cmp_eq_u32 s50, s41
    s_cselect_b32 s44, 0, s44
attn_kernel_dk23:
    v_add_f32 v243, v243, v149
    v_add_f32 v233, v233, v150
    v_add_f32 v243, v243, v151
    v_add_f32 v233, v233, v152
    v_add_f32 v243, v243, v153
    s_waitcnt lgkmcnt(7)
    v_mfma_f32_32x32x16_bf16 v[52:67], v[208:211], v[168:171], v[52:67]
    ds_read_b128 v[208:211], v230 offset:60416
    s_cmp_lg_u32 s42, 15
    s_cbranch_scc1 attn_kernel_wp25
    v_lshlrev_b32 v244, 4, v0
    buffer_load_dwordx4 v[248:251], v244, s[60:63], 0 offen
    buffer_load_dwordx4 v[248:251], v244, s[64:67], 0 offen
    buffer_load_dwordx4 v[248:251], v244, s[68:71], 0 offen
    buffer_load_dwordx4 v[248:251], v244, s[72:75], 0 offen
    buffer_load_dwordx4 v[248:251], v244, s[76:79], 0 offen
attn_kernel_wp25:
    v_add_f32 v233, v233, v154
    v_add_f32 v243, v243, v155
    v_exp_f32 v156, v156
    s_nop 1
    s_waitcnt lgkmcnt(7)
    v_mfma_f32_32x32x16_bf16 v[4:19], v[180:183], v[172:175], v[4:19]
    ds_read_b128 v[180:183], v228 offset:32768
    v_exp_f32 v157, v157
    v_exp_f32 v158, v158
    v_exp_f32 v159, v159
    s_waitcnt lgkmcnt(7)
    v_mfma_f32_32x32x16_bf16 v[20:35], v[184:187], v[172:175], v[20:35]
    ds_read_b128 v[184:187], v228 offset:40960
    v_exp_f32 v160, v160
    v_exp_f32 v161, v161
    v_exp_f32 v162, v162
    s_waitcnt lgkmcnt(7)
    v_mfma_f32_32x32x16_bf16 v[36:51], v[188:191], v[172:175], v[36:51]
    ds_read_b128 v[188:191], v228 offset:33792
    v_exp_f32 v163, v163
    v_cvt_pk_bf16_f32 v176, v156, v157
    v_cvt_pk_bf16_f32 v177, v158, v159
    s_waitcnt lgkmcnt(7)
    v_mfma_f32_32x32x16_bf16 v[52:67], v[192:195], v[172:175], v[52:67]
    ds_read_b128 v[192:195], v228 offset:41984
    v_cvt_pk_bf16_f32 v178, v160, v161
    v_cvt_pk_bf16_f32 v179, v162, v163
    s_nop 1
    s_waitcnt lgkmcnt(7)
    v_mfma_f32_32x32x16_bf16 v[4:19], v[196:199], v[176:179], v[4:19]
    ds_read_b128 v[196:199], v228 offset:34816
    v_add_f32 v233, v233, v156
    v_add_f32 v243, v243, v157
    v_add_f32 v233, v233, v158
    s_waitcnt lgkmcnt(7)
    v_mfma_f32_32x32x16_bf16 v[20:35], v[200:203], v[176:179], v[20:35]
    ds_read_b128 v[200:203], v228 offset:43008
    v_add_f32 v243, v243, v159
    v_add_f32 v233, v233, v160
    v_add_f32 v243, v243, v161
    v_add_f32 v233, v233, v162
    v_add_f32 v243, v243, v163
    s_waitcnt lgkmcnt(7)
    v_mfma_f32_32x32x16_bf16 v[36:51], v[204:207], v[176:179], v[36:51]
    ds_read_b128 v[204:207], v228 offset:35840
    s_waitcnt lgkmcnt(7)
    v_mfma_f32_32x32x16_bf16 v[52:67], v[208:211], v[176:179], v[52:67]
    ds_read_b128 v[208:211], v228 offset:44032
    s_add_u32 s42, s42, 1
    s_branch attn_kernel_loop0
attn_kernel_last0:
    v_cmp_gt_i32 s[52:53], 0, v239
    v_cmp_gt_i32 s[54:55], 1, v239
    v_cmp_gt_i32 s[56:57], 2, v239
    v_cmp_gt_i32 s[58:59], 3, v239
    v_cndmask_b32 v100, v100, v238, s[52:53]
    v_cndmask_b32 v101, v101, v238, s[54:55]
    v_cndmask_b32 v102, v102, v238, s[56:57]
    s_waitcnt lgkmcnt(7)
    v_mfma_f32_32x32x16_bf16 v[132:147], v[180:183], v[68:71], 0
    ds_read_b128 v[180:183], v228 offset:36864
    v_cndmask_b32 v103, v103, v238, s[58:59]
    v_cmp_gt_i32 s[52:53], 8, v239
    v_cmp_gt_i32 s[54:55], 9, v239
    v_cmp_gt_i32 s[56:57], 10, v239
    v_cmp_gt_i32 s[58:59], 11, v239
    v_cndmask_b32 v104, v104, v238, s[52:53]
    v_cndmask_b32 v105, v105, v238, s[54:55]
    s_waitcnt lgkmcnt(7)
    v_mfma_f32_32x32x16_bf16 v[148:163], v[184:187], v[68:71], 0
    ds_read_b128 v[184:187], v228 offset:45056
    v_cndmask_b32 v106, v106, v238, s[56:57]
    v_cndmask_b32 v107, v107, v238, s[58:59]
    v_cmp_gt_i32 s[52:53], 16, v239
    v_cmp_gt_i32 s[54:55], 17, v239
    v_cmp_gt_i32 s[56:57], 18, v239
    v_cmp_gt_i32 s[58:59], 19, v239
    v_cndmask_b32 v108, v108, v238, s[52:53]
    s_waitcnt lgkmcnt(7)
    v_mfma_f32_32x32x16_bf16 v[132:147], v[188:191], v[72:75], v[132:147]
    ds_read_b128 v[188:191], v228 offset:37888
    v_cndmask_b32 v109, v109, v238, s[54:55]
    v_cndmask_b32 v110, v110, v238, s[56:57]
    v_cndmask_b32 v111, v111, v238, s[58:59]
    v_cmp_gt_i32 s[52:53], 24, v239
    v_cmp_gt_i32 s[54:55], 25, v239
    v_cmp_gt_i32 s[56:57], 26, v239
    v_cmp_gt_i32 s[58:59], 27, v239
    s_waitcnt lgkmcnt(7)
    v_mfma_f32_32x32x16_bf16 v[148:163], v[192:195], v[72:75], v[148:163]
    ds_read_b128 v[192:195], v228 offset:46080
    v_cndmask_b32 v112, v112, v238, s[52:53]
    v_cndmask_b32 v113, v113, v238, s[54:55]
    v_cndmask_b32 v114, v114, v238, s[56:57]
    v_cndmask_b32 v115, v115, v238, s[58:59]
    v_cmp_gt_i32 s[52:53], 32, v239
    v_cmp_gt_i32 s[54:55], 33, v239
    v_cmp_gt_i32 s[56:57], 34, v239
    s_waitcnt lgkmcnt(7)
    v_mfma_f32_32x32x16_bf16 v[132:147], v[196:199], v[76:79], v[132:147]
    ds_read_b128 v[196:199], v228 offset:38912
    v_cmp_gt_i32 s[58:59], 35, v239
    v_cndmask_b32 v116, v116, v238, s[52:53]
    v_cndmask_b32 v117, v117, v238, s[54:55]
    v_cndmask_b32 v118, v118, v238, s[56:57]
    v_cndmask_b32 v119, v119, v238, s[58:59]
    v_cmp_gt_i32 s[52:53], 40, v239
    s_waitcnt lgkmcnt(7)
    v_mfma_f32_32x32x16_bf16 v[148:163], v[200:203], v[76:79], v[148:163]
    ds_read_b128 v[200:203], v228 offset:47104
    v_cmp_gt_i32 s[54:55], 41, v239
    v_cmp_gt_i32 s[56:57], 42, v239
    v_cmp_gt_i32 s[58:59], 43, v239
    v_cndmask_b32 v120, v120, v238, s[52:53]
    v_cndmask_b32 v121, v121, v238, s[54:55]
    v_cndmask_b32 v122, v122, v238, s[56:57]
    v_cndmask_b32 v123, v123, v238, s[58:59]
    s_waitcnt lgkmcnt(7)
    v_mfma_f32_32x32x16_bf16 v[132:147], v[204:207], v[80:83], v[132:147]
    ds_read_b128 v[204:207], v228 offset:39936
    v_cmp_gt_i32 s[52:53], 48, v239
    v_cmp_gt_i32 s[54:55], 49, v239
    v_cmp_gt_i32 s[56:57], 50, v239
    v_cmp_gt_i32 s[58:59], 51, v239
    v_cndmask_b32 v124, v124, v238, s[52:53]
    v_cndmask_b32 v125, v125, v238, s[54:55]
    v_cndmask_b32 v126, v126, v238, s[56:57]
    s_waitcnt lgkmcnt(7)
    v_mfma_f32_32x32x16_bf16 v[148:163], v[208:211], v[80:83], v[148:163]
    ds_read_b128 v[208:211], v228 offset:48128
    v_cndmask_b32 v127, v127, v238, s[58:59]
    v_cmp_gt_i32 s[52:53], 56, v239
    v_cmp_gt_i32 s[54:55], 57, v239
    v_cmp_gt_i32 s[56:57], 58, v239
    v_cmp_gt_i32 s[58:59], 59, v239
    v_cndmask_b32 v128, v128, v238, s[52:53]
    v_cndmask_b32 v129, v129, v238, s[54:55]
    s_waitcnt vmcnt(5) lgkmcnt(0)
    s_cmp_eq_u32 s42, 16
    s_cbranch_scc1 attn_kernel_g38
    s_waitcnt vmcnt(0)
attn_kernel_g38:
    s_barrier
    v_mfma_f32_32x32x16_bf16 v[132:147], v[180:183], v[84:87], v[132:147]
    ds_read_b128 v[180:183], v230 offset:0
    s_cmp_ge_u32 s51, 17
    s_cbranch_scc1 attn_kernel_dv29
    s_add_u32 s36, s45, 0x0
    s_add_u32 m0, s31, 0x18000
    s_nop 0
    buffer_load_dwordx4 v240, s[12:15], s36 offen lds
attn_kernel_dv29:
    v_cndmask_b32 v130, v130, v238, s[56:57]
    v_cndmask_b32 v131, v131, v238, s[58:59]
    v_max3_f32 v234, v100, v101, v102
    v_max3_f32 v235, v103, v104, v105
    v_max3_f32 v234, v234, v106, v107
    v_max3_f32 v235, v235, v108, v109
    v_max3_f32 v234, v234, v110, v111
    s_waitcnt lgkmcnt(7)
    v_mfma_f32_32x32x16_bf16 v[148:163], v[184:187], v[84:87], v[148:163]
    ds_read_b128 v[184:187], v230 offset:8192
    v_max3_f32 v235, v235, v112, v113
    v_max3_f32 v234, v234, v114, v115
    v_max3_f32 v235, v235, v116, v117
    v_max3_f32 v234, v234, v118, v119
    v_max3_f32 v235, v235, v120, v121
    v_max3_f32 v234, v234, v122, v123
    v_max3_f32 v235, v235, v124, v125
    s_waitcnt lgkmcnt(7)
    v_mfma_f32_32x32x16_bf16 v[132:147], v[188:191], v[88:91], v[132:147]
    ds_read_b128 v[188:191], v230 offset:16384
    s_cmp_ge_u32 s51, 17
    s_cbranch_scc1 attn_kernel_dv30
    s_add_u32 s36, s45, 0x2000
    s_add_u32 m0, s31, 0x1a000
    s_nop 0
    buffer_load_dwordx4 v240, s[12:15], s36 offen lds
attn_kernel_dv30:
    v_max3_f32 v234, v234, v126, v127
    v_max3_f32 v235, v235, v128, v129
    v_max3_f32 v234, v234, v130, v131
    v_max_f32 v234, v234, v235
    v_mov_b32 v235, v234
    s_nop 1
    v_permlane32_swap_b32 v235, v234
    s_waitcnt lgkmcnt(7)
    v_mfma_f32_32x32x16_bf16 v[148:163], v[192:195], v[88:91], v[148:163]
    ds_read_b128 v[192:195], v230 offset:24576
    v_max_f32 v234, v234, v235
    v_cmp_lt_f32 vcc, 0x41000000, v234
    s_or_b32 s36, vcc_lo, s80
    s_or_b32 s36, s36, vcc_hi
    s_cbranch_scc0 attn_kernel_nr27
    v_add_f32 v235, v234, v247
    v_add_f32 v237, 0x41000000, v232
    v_cmp_gt_f32 vcc, v235, v237
    v_cndmask_b32 v236, v232, v235, vcc
    v_sub_f32 v237, v232, v236
    v_sub_f32 v235, v247, v236
    v_exp_f32 v237, v237
    s_mov_b32 s36, 0xf0000000
    v_cmp_lt_f32 s[52:53], s36, v232
    s_and_b64 s[52:53], s[52:53], vcc
    v_cmp_neq_f32 vcc, v231, v236
    v_mov_b32 v247, v231
    v_mov_b32 v231, v236
    v_mov_b32 v232, v236
    s_or_b32 s80, vcc_lo, vcc_hi
    v_add_f32 v100, v100, v235
    v_add_f32 v101, v101, v235
    v_add_f32 v102, v102, v235
    v_add_f32 v103, v103, v235
    v_add_f32 v104, v104, v235
    v_add_f32 v105, v105, v235
    v_add_f32 v106, v106, v235
    v_add_f32 v107, v107, v235
    v_add_f32 v108, v108, v235
    v_add_f32 v109, v109, v235
    v_add_f32 v110, v110, v235
    v_add_f32 v111, v111, v235
    v_add_f32 v112, v112, v235
    v_add_f32 v113, v113, v235
    v_add_f32 v114, v114, v235
    v_add_f32 v115, v115, v235
    v_add_f32 v116, v116, v235
    v_add_f32 v117, v117, v235
    v_add_f32 v118, v118, v235
    v_add_f32 v119, v119, v235
    v_add_f32 v120, v120, v235
    v_add_f32 v121, v121, v235
    v_add_f32 v122, v122, v235
    v_add_f32 v123, v123, v235
    v_add_f32 v124, v124, v235
    v_add_f32 v125, v125, v235
    v_add_f32 v126, v126, v235
    v_add_f32 v127, v127, v235
    v_add_f32 v128, v128, v235
    v_add_f32 v129, v129, v235
    v_add_f32 v130, v130, v235
    v_add_f32 v131, v131, v235
    s_cmp_eq_u32 s80, 0
    s_cbranch_scc1 attn_kernel_n128
    v_sub_f32 v212, 0, v236
    v_sub_f32 v213, 0, v236
    v_sub_f32 v214, 0, v236
    v_sub_f32 v215, 0, v236
    v_sub_f32 v216, 0, v236
    v_sub_f32 v217, 0, v236
    v_sub_f32 v218, 0, v236
    v_sub_f32 v219, 0, v236
    v_sub_f32 v220, 0, v236
    v_sub_f32 v221, 0, v236
    v_sub_f32 v222, 0, v236
    v_sub_f32 v223, 0, v236
    v_sub_f32 v224, 0, v236
    v_sub_f32 v225, 0, v236
    v_sub_f32 v226, 0, v236
    v_sub_f32 v227, 0, v236
    attn_kernel_n128:
    s_cmp_eq_u64 s[52:53], 0
    s_cbranch_scc1 attn_kernel_nr27
    v_mul_f32 v4, v4, v237
    v_mul_f32 v5, v5, v237
    v_mul_f32 v6, v6, v237
    v_mul_f32 v7, v7, v237
    v_mul_f32 v8, v8, v237
    v_mul_f32 v9, v9, v237
    v_mul_f32 v10, v10, v237
    v_mul_f32 v11, v11, v237
    v_mul_f32 v12, v12, v237
    v_mul_f32 v13, v13, v237
    v_mul_f32 v14, v14, v237
    v_mul_f32 v15, v15, v237
    v_mul_f32 v16, v16, v237
    v_mul_f32 v17, v17, v237
    v_mul_f32 v18, v18, v237
    v_mul_f32 v19, v19, v237
    v_mul_f32 v20, v20, v237
    v_mul_f32 v21, v21, v237
    v_mul_f32 v22, v22, v237
    v_mul_f32 v23, v23, v237
    v_mul_f32 v24, v24, v237
    v_mul_f32 v25, v25, v237
    v_mul_f32 v26, v26, v237
    v_mul_f32 v27, v27, v237
    v_mul_f32 v28, v28, v237
    v_mul_f32 v29, v29, v237
    v_mul_f32 v30, v30, v237
    v_mul_f32 v31, v31, v237
    v_mul_f32 v32, v32, v237
    v_mul_f32 v33, v33, v237
    v_mul_f32 v34, v34, v237
    v_mul_f32 v35, v35, v237
    v_mul_f32 v36, v36, v237
    v_mul_f32 v37, v37, v237
    v_mul_f32 v38, v38, v237
    v_mul_f32 v39, v39, v237
    v_mul_f32 v40, v40, v237
    v_mul_f32 v41, v41, v237
    v_mul_f32 v42, v42, v237
    v_mul_f32 v43, v43, v237
    v_mul_f32 v44, v44, v237
    v_mul_f32 v45, v45, v237
    v_mul_f32 v46, v46, v237
    v_mul_f32 v47, v47, v237
    v_mul_f32 v48, v48, v237
    v_mul_f32 v49, v49, v237
    v_mul_f32 v50, v50, v237
    v_mul_f32 v51, v51, v237
    v_mul_f32 v52, v52, v237
    v_mul_f32 v53, v53, v237
    v_mul_f32 v54, v54, v237
    v_mul_f32 v55, v55, v237
    v_mul_f32 v56, v56, v237
    v_mul_f32 v57, v57, v237
    v_mul_f32 v58, v58, v237
    v_mul_f32 v59, v59, v237
    v_mul_f32 v60, v60, v237
    v_mul_f32 v61, v61, v237
    v_mul_f32 v62, v62, v237
    v_mul_f32 v63, v63, v237
    v_mul_f32 v64, v64, v237
    v_mul_f32 v65, v65, v237
    v_mul_f32 v66, v66, v237
    v_mul_f32 v67, v67, v237
    v_mul_f32 v233, v233, v237
    v_mul_f32 v243, v243, v237
attn_kernel_nr27:
    v_exp_f32 v100, v100
    s_waitcnt lgkmcnt(7)
    v_mfma_f32_32x32x16_bf16 v[132:147], v[196:199], v[92:95], v[132:147]
    ds_read_b128 v[196:199], v230 offset:1024
    s_cmp_ge_u32 s51, 17
    s_cbranch_scc1 attn_kernel_dv31
    s_add_u32 s36, s45, 0x4000
    s_add_u32 m0, s31, 0x1c000
    s_nop 0
    buffer_load_dwordx4 v240, s[12:15], s36 offen lds
attn_kernel_dv31:
    v_exp_f32 v101, v101
    v_exp_f32 v102, v102
    v_exp_f32 v103, v103
    s_waitcnt lgkmcnt(7)
    v_mfma_f32_32x32x16_bf16 v[148:163], v[200:203], v[92:95], v[148:163]
    ds_read_b128 v[200:203], v230 offset:9216
    v_exp_f32 v104, v104
    v_exp_f32 v105, v105
    v_exp_f32 v106, v106
    s_waitcnt lgkmcnt(7)
    v_mfma_f32_32x32x16_bf16 v[132:147], v[204:207], v[96:99], v[132:147]
    ds_read_b128 v[204:207], v230 offset:17408
    s_cmp_ge_u32 s51, 17
    s_cbranch_scc1 attn_kernel_dv32
    s_add_u32 s36, s45, 0x6000
    s_add_u32 m0, s31, 0x1e000
    s_nop 0
    buffer_load_dwordx4 v240, s[12:15], s36 offen lds
    s_add_u32 s45, s45, 0x8000
    s_add_u32 s51, s51, 1
    s_cmp_eq_u32 s51, s41
    s_cselect_b32 s45, 0, s45
attn_kernel_dv32:
    v_exp_f32 v107, v107
    v_cvt_pk_bf16_f32 v164, v100, v101
    v_cvt_pk_bf16_f32 v165, v102, v103
    v_cvt_pk_bf16_f32 v166, v104, v105
    v_cvt_pk_bf16_f32 v167, v106, v107
    s_waitcnt lgkmcnt(7)
    v_mfma_f32_32x32x16_bf16 v[148:163], v[208:211], v[96:99], v[148:163]
    ds_read_b128 v[208:211], v230 offset:25600
    v_add_f32 v233, v233, v100
    v_add_f32 v243, v243, v101
    v_add_f32 v233, v233, v102
    v_add_f32 v243, v243, v103
    v_add_f32 v233, v233, v104
    v_add_f32 v243, v243, v105
    v_add_f32 v233, v233, v106
    s_nop 1
    s_waitcnt lgkmcnt(7)
    v_mfma_f32_32x32x16_bf16 v[4:19], v[180:183], v[164:167], v[4:19]
    ds_read_b128 v[180:183], v230 offset:2048
    s_cmp_ge_u32 s50, 17
    s_cbranch_scc1 attn_kernel_dk33
    s_add_u32 s36, s44, 0x0
    s_add_u32 m0, s31, 0x8000
    s_nop 0
    buffer_load_dwordx4 v240, s[24:27], s36 offen lds
attn_kernel_dk33:
    v_add_f32 v243, v243, v107
    v_exp_f32 v108, v108
    v_exp_f32 v109, v109
    v_exp_f32 v110, v110
    s_waitcnt lgkmcnt(7)
    v_mfma_f32_32x32x16_bf16 v[20:35], v[184:187], v[164:167], v[20:35]
    ds_read_b128 v[184:187], v230 offset:10240
    v_exp_f32 v111, v111
    v_exp_f32 v112, v112
    v_exp_f32 v113, v113
    s_waitcnt lgkmcnt(7)
    v_mfma_f32_32x32x16_bf16 v[36:51], v[188:191], v[164:167], v[36:51]
    ds_read_b128 v[188:191], v230 offset:18432
    s_cmp_ge_u32 s50, 17
    s_cbranch_scc1 attn_kernel_dk34
    s_add_u32 s36, s44, 0x2000
    s_add_u32 m0, s31, 0xa000
    s_nop 0
    buffer_load_dwordx4 v240, s[24:27], s36 offen lds
attn_kernel_dk34:
    v_exp_f32 v114, v114
    v_exp_f32 v115, v115
    v_cvt_pk_bf16_f32 v168, v108, v109
    s_waitcnt lgkmcnt(7)
    v_mfma_f32_32x32x16_bf16 v[52:67], v[192:195], v[164:167], v[52:67]
    ds_read_b128 v[192:195], v230 offset:26624
    v_cvt_pk_bf16_f32 v169, v110, v111
    v_cvt_pk_bf16_f32 v170, v112, v113
    v_cvt_pk_bf16_f32 v171, v114, v115
    v_add_f32 v233, v233, v108
    v_add_f32 v243, v243, v109
    v_add_f32 v233, v233, v110
    s_nop 1
    s_waitcnt lgkmcnt(7)
    v_mfma_f32_32x32x16_bf16 v[4:19], v[196:199], v[168:171], v[4:19]
    ds_read_b128 v[196:199], v230 offset:3072
    s_cmp_ge_u32 s50, 17
    s_cbranch_scc1 attn_kernel_dk35
    s_add_u32 s36, s44, 0x4000
    s_add_u32 m0, s31, 0xc000
    s_nop 0
    buffer_load_dwordx4 v240, s[24:27], s36 offen lds
attn_kernel_dk35:
    v_add_f32 v243, v243, v111
    v_add_f32 v233, v233, v112
    v_add_f32 v243, v243, v113
    v_add_f32 v233, v233, v114
    v_add_f32 v243, v243, v115
    s_waitcnt lgkmcnt(7)
    v_mfma_f32_32x32x16_bf16 v[20:35], v[200:203], v[168:171], v[20:35]
    ds_read_b128 v[200:203], v230 offset:11264
    v_exp_f32 v116, v116
    v_exp_f32 v117, v117
    v_exp_f32 v118, v118
    v_exp_f32 v119, v119
    s_waitcnt lgkmcnt(7)
    v_mfma_f32_32x32x16_bf16 v[36:51], v[204:207], v[168:171], v[36:51]
    ds_read_b128 v[204:207], v230 offset:19456
    s_cmp_ge_u32 s50, 17
    s_cbranch_scc1 attn_kernel_dk36
    s_add_u32 s36, s44, 0x6000
    s_add_u32 m0, s31, 0xe000
    s_nop 0
    buffer_load_dwordx4 v240, s[24:27], s36 offen lds
    s_add_u32 s44, s44, 0x8000
    s_add_u32 s50, s50, 1
    s_cmp_eq_u32 s50, s41
    s_cselect_b32 s44, 0, s44
attn_kernel_dk36:
    v_exp_f32 v120, v120
    v_exp_f32 v121, v121
    v_exp_f32 v122, v122
    v_exp_f32 v123, v123
    s_waitcnt lgkmcnt(7)
    v_mfma_f32_32x32x16_bf16 v[52:67], v[208:211], v[168:171], v[52:67]
    ds_read_b128 v[208:211], v230 offset:27648
    s_cmp_lg_u32 s42, 15
    s_cbranch_scc1 attn_kernel_wp37
    v_lshlrev_b32 v244, 4, v0
    buffer_load_dwordx4 v[248:251], v244, s[60:63], 0 offen
    buffer_load_dwordx4 v[248:251], v244, s[64:67], 0 offen
    buffer_load_dwordx4 v[248:251], v244, s[68:71], 0 offen
    buffer_load_dwordx4 v[248:251], v244, s[72:75], 0 offen
    buffer_load_dwordx4 v[248:251], v244, s[76:79], 0 offen
attn_kernel_wp37:
    v_cvt_pk_bf16_f32 v172, v116, v117
    v_cvt_pk_bf16_f32 v173, v118, v119
    v_cvt_pk_bf16_f32 v174, v120, v121
    v_cvt_pk_bf16_f32 v175, v122, v123
    s_nop 1
    s_waitcnt lgkmcnt(7)
    v_mfma_f32_32x32x16_bf16 v[4:19], v[180:183], v[172:175], v[4:19]
    ds_read_b128 v[180:183], v228 offset:0
    v_add_f32 v233, v233, v116
    v_add_f32 v243, v243, v117
    v_add_f32 v233, v233, v118
    v_add_f32 v243, v243, v119
    v_add_f32 v233, v233, v120
    s_waitcnt lgkmcnt(7)
    v_mfma_f32_32x32x16_bf16 v[20:35], v[184:187], v[172:175], v[20:35]
    ds_read_b128 v[184:187], v228 offset:8192
    v_add_f32 v243, v243, v121
    v_add_f32 v233, v233, v122
    v_add_f32 v243, v243, v123
    v_exp_f32 v124, v124
    v_exp_f32 v125, v125
    s_waitcnt lgkmcnt(7)
    v_mfma_f32_32x32x16_bf16 v[36:51], v[188:191], v[172:175], v[36:51]
    ds_read_b128 v[188:191], v228 offset:1024
    v_exp_f32 v126, v126
    v_exp_f32 v127, v127
    v_exp_f32 v128, v128
    v_exp_f32 v129, v129
    v_exp_f32 v130, v130
    s_waitcnt lgkmcnt(7)
    v_mfma_f32_32x32x16_bf16 v[52:67], v[192:195], v[172:175], v[52:67]
    ds_read_b128 v[192:195], v228 offset:9216
    v_exp_f32 v131, v131
    v_cvt_pk_bf16_f32 v176, v124, v125
    v_cvt_pk_bf16_f32 v177, v126, v127
    v_cvt_pk_bf16_f32 v178, v128, v129
    v_cvt_pk_bf16_f32 v179, v130, v131
    s_nop 1
    s_waitcnt lgkmcnt(7)
    v_mfma_f32_32x32x16_bf16 v[4:19], v[196:199], v[176:179], v[4:19]
    ds_read_b128 v[196:199], v228 offset:2048
    v_add_f32 v233, v233, v124
    v_add_f32 v243, v243, v125
    v_add_f32 v233, v233, v126
    s_waitcnt lgkmcnt(7)
    v_mfma_f32_32x32x16_bf16 v[20:35], v[200:203], v[176:179], v[20:35]
    ds_read_b128 v[200:203], v228 offset:10240
    v_add_f32 v243, v243, v127
    v_add_f32 v233, v233, v128
    v_add_f32 v243, v243, v129
    v_add_f32 v233, v233, v130
    v_add_f32 v243, v243, v131
    s_waitcnt lgkmcnt(7)
    v_mfma_f32_32x32x16_bf16 v[36:51], v[204:207], v[176:179], v[36:51]
    ds_read_b128 v[204:207], v228 offset:3072
    s_waitcnt lgkmcnt(7)
    v_mfma_f32_32x32x16_bf16 v[52:67], v[208:211], v[176:179], v[52:67]
    ds_read_b128 v[208:211], v228 offset:11264
    s_mov_b32 s38, 0x10000
    s_branch attn_kernel_fin
attn_kernel_last1:
    v_cmp_gt_i32 s[52:53], 0, v239
    v_cmp_gt_i32 s[54:55], 1, v239
    v_cmp_gt_i32 s[56:57], 2, v239
    v_cmp_gt_i32 s[58:59], 3, v239
    v_cndmask_b32 v132, v132, v238, s[52:53]
    v_cndmask_b32 v133, v133, v238, s[54:55]
    v_cndmask_b32 v134, v134, v238, s[56:57]
    s_waitcnt lgkmcnt(7)
    v_mfma_f32_32x32x16_bf16 v[100:115], v[180:183], v[68:71], 0
    ds_read_b128 v[180:183], v228 offset:4096
    v_cndmask_b32 v135, v135, v238, s[58:59]
    v_cmp_gt_i32 s[52:53], 8, v239
    v_cmp_gt_i32 s[54:55], 9, v239
    v_cmp_gt_i32 s[56:57], 10, v239
    v_cmp_gt_i32 s[58:59], 11, v239
    v_cndmask_b32 v136, v136, v238, s[52:53]
    v_cndmask_b32 v137, v137, v238, s[54:55]
    s_waitcnt lgkmcnt(7)
    v_mfma_f32_32x32x16_bf16 v[116:131], v[184:187], v[68:71], 0
    ds_read_b128 v[184:187], v228 offset:12288
    v_cndmask_b32 v138, v138, v238, s[56:57]
    v_cndmask_b32 v139, v139, v238, s[58:59]
    v_cmp_gt_i32 s[52:53], 16, v239
    v_cmp_gt_i32 s[54:55], 17, v239
    v_cmp_gt_i32 s[56:57], 18, v239
    v_cmp_gt_i32 s[58:59], 19, v239
    v_cndmask_b32 v140, v140, v238, s[52:53]
    s_waitcnt lgkmcnt(7)
    v_mfma_f32_32x32x16_bf16 v[100:115], v[188:191], v[72:75], v[100:115]
    ds_read_b128 v[188:191], v228 offset:5120
    v_cndmask_b32 v141, v141, v238, s[54:55]
    v_cndmask_b32 v142, v142, v238, s[56:57]
    v_cndmask_b32 v143, v143, v238, s[58:59]
    v_cmp_gt_i32 s[52:53], 24, v239
    v_cmp_gt_i32 s[54:55], 25, v239
    v_cmp_gt_i32 s[56:57], 26, v239
    v_cmp_gt_i32 s[58:59], 27, v239
    s_waitcnt lgkmcnt(7)
    v_mfma_f32_32x32x16_bf16 v[116:131], v[192:195], v[72:75], v[116:131]
    ds_read_b128 v[192:195], v228 offset:13312
    v_cndmask_b32 v144, v144, v238, s[52:53]
    v_cndmask_b32 v145, v145, v238, s[54:55]
    v_cndmask_b32 v146, v146, v238, s[56:57]
    v_cndmask_b32 v147, v147, v238, s[58:59]
    v_cmp_gt_i32 s[52:53], 32, v239
    v_cmp_gt_i32 s[54:55], 33, v239
    v_cmp_gt_i32 s[56:57], 34, v239
    s_waitcnt lgkmcnt(7)
    v_mfma_f32_32x32x16_bf16 v[100:115], v[196:199], v[76:79], v[100:115]
    ds_read_b128 v[196:199], v228 offset:6144
    v_cmp_gt_i32 s[58:59], 35, v239
    v_cndmask_b32 v148, v148, v238, s[52:53]
    v_cndmask_b32 v149, v149, v238, s[54:55]
    v_cndmask_b32 v150, v150, v238, s[56:57]
    v_cndmask_b32 v151, v151, v238, s[58:59]
    v_cmp_gt_i32 s[52:53], 40, v239
    s_waitcnt lgkmcnt(7)
    v_mfma_f32_32x32x16_bf16 v[116:131], v[200:203], v[76:79], v[116:131]
    ds_read_b128 v[200:203], v228 offset:14336
    v_cmp_gt_i32 s[54:55], 41, v239
    v_cmp_gt_i32 s[56:57], 42, v239
    v_cmp_gt_i32 s[58:59], 43, v239
    v_cndmask_b32 v152, v152, v238, s[52:53]
    v_cndmask_b32 v153, v153, v238, s[54:55]
    v_cndmask_b32 v154, v154, v238, s[56:57]
    v_cndmask_b32 v155, v155, v238, s[58:59]
    s_waitcnt lgkmcnt(7)
    v_mfma_f32_32x32x16_bf16 v[100:115], v[204:207], v[80:83], v[100:115]
    ds_read_b128 v[204:207], v228 offset:7168
    v_cmp_gt_i32 s[52:53], 48, v239
    v_cmp_gt_i32 s[54:55], 49, v239
    v_cmp_gt_i32 s[56:57], 50, v239
    v_cmp_gt_i32 s[58:59], 51, v239
    v_cndmask_b32 v156, v156, v238, s[52:53]
    v_cndmask_b32 v157, v157, v238, s[54:55]
    v_cndmask_b32 v158, v158, v238, s[56:57]
    s_waitcnt lgkmcnt(7)
    v_mfma_f32_32x32x16_bf16 v[116:131], v[208:211], v[80:83], v[116:131]
    ds_read_b128 v[208:211], v228 offset:15360
    v_cndmask_b32 v159, v159, v238, s[58:59]
    v_cmp_gt_i32 s[52:53], 56, v239
    v_cmp_gt_i32 s[54:55], 57, v239
    v_cmp_gt_i32 s[56:57], 58, v239
    v_cmp_gt_i32 s[58:59], 59, v239
    v_cndmask_b32 v160, v160, v238, s[52:53]
    v_cndmask_b32 v161, v161, v238, s[54:55]
    s_waitcnt vmcnt(5) lgkmcnt(0)
    s_cmp_eq_u32 s42, 16
    s_cbranch_scc1 attn_kernel_g50
    s_waitcnt vmcnt(0)
attn_kernel_g50:
    s_barrier
    v_mfma_f32_32x32x16_bf16 v[100:115], v[180:183], v[84:87], v[100:115]
    ds_read_b128 v[180:183], v230 offset:32768
    s_cmp_ge_u32 s51, 17
    s_cbranch_scc1 attn_kernel_dv41
    s_add_u32 s36, s45, 0x0
    s_add_u32 m0, s31, 0x10000
    s_nop 0
    buffer_load_dwordx4 v240, s[12:15], s36 offen lds
attn_kernel_dv41:
    v_cndmask_b32 v162, v162, v238, s[56:57]
    v_cndmask_b32 v163, v163, v238, s[58:59]
    v_max3_f32 v234, v132, v133, v134
    v_max3_f32 v235, v135, v136, v137
    v_max3_f32 v234, v234, v138, v139
    v_max3_f32 v235, v235, v140, v141
    v_max3_f32 v234, v234, v142, v143
    s_waitcnt lgkmcnt(7)
    v_mfma_f32_32x32x16_bf16 v[116:131], v[184:187], v[84:87], v[116:131]
    ds_read_b128 v[184:187], v230 offset:40960
    v_max3_f32 v235, v235, v144, v145
    v_max3_f32 v234, v234, v146, v147
    v_max3_f32 v235, v235, v148, v149
    v_max3_f32 v234, v234, v150, v151
    v_max3_f32 v235, v235, v152, v153
    v_max3_f32 v234, v234, v154, v155
    v_max3_f32 v235, v235, v156, v157
    s_waitcnt lgkmcnt(7)
    v_mfma_f32_32x32x16_bf16 v[100:115], v[188:191], v[88:91], v[100:115]
    ds_read_b128 v[188:191], v230 offset:49152
    s_cmp_ge_u32 s51, 17
    s_cbranch_scc1 attn_kernel_dv42
    s_add_u32 s36, s45, 0x2000
    s_add_u32 m0, s31, 0x12000
    s_nop 0
    buffer_load_dwordx4 v240, s[12:15], s36 offen lds
attn_kernel_dv42:
    v_max3_f32 v234, v234, v158, v159
    v_max3_f32 v235, v235, v160, v161
    v_max3_f32 v234, v234, v162, v163
    v_max_f32 v234, v234, v235
    v_mov_b32 v235, v234
    s_nop 1
    v_permlane32_swap_b32 v235, v234
    s_waitcnt lgkmcnt(7)
    v_mfma_f32_32x32x16_bf16 v[116:131], v[192:195], v[88:91], v[116:131]
    ds_read_b128 v[192:195], v230 offset:57344
    v_max_f32 v234, v234, v235
    v_cmp_lt_f32 vcc, 0x41000000, v234
    s_or_b32 s36, vcc_lo, s80
    s_or_b32 s36, s36, vcc_hi
    s_cbranch_scc0 attn_kernel_nr39
    v_add_f32 v235, v234, v247
    v_add_f32 v237, 0x41000000, v232
    v_cmp_gt_f32 vcc, v235, v237
    v_cndmask_b32 v236, v232, v235, vcc
    v_sub_f32 v237, v232, v236
    v_sub_f32 v235, v247, v236
    v_exp_f32 v237, v237
    s_mov_b32 s36, 0xf0000000
    v_cmp_lt_f32 s[52:53], s36, v232
    s_and_b64 s[52:53], s[52:53], vcc
    v_cmp_neq_f32 vcc, v231, v236
    v_mov_b32 v247, v231
    v_mov_b32 v231, v236
    v_mov_b32 v232, v236
    s_or_b32 s80, vcc_lo, vcc_hi
    v_add_f32 v132, v132, v235
    v_add_f32 v133, v133, v235
    v_add_f32 v134, v134, v235
    v_add_f32 v135, v135, v235
    v_add_f32 v136, v136, v235
    v_add_f32 v137, v137, v235
    v_add_f32 v138, v138, v235
    v_add_f32 v139, v139, v235
    v_add_f32 v140, v140, v235
    v_add_f32 v141, v141, v235
    v_add_f32 v142, v142, v235
    v_add_f32 v143, v143, v235
    v_add_f32 v144, v144, v235
    v_add_f32 v145, v145, v235
    v_add_f32 v146, v146, v235
    v_add_f32 v147, v147, v235
    v_add_f32 v148, v148, v235
    v_add_f32 v149, v149, v235
    v_add_f32 v150, v150, v235
    v_add_f32 v151, v151, v235
    v_add_f32 v152, v152, v235
    v_add_f32 v153, v153, v235
    v_add_f32 v154, v154, v235
    v_add_f32 v155, v155, v235
    v_add_f32 v156, v156, v235
    v_add_f32 v157, v157, v235
    v_add_f32 v158, v158, v235
    v_add_f32 v159, v159, v235
    v_add_f32 v160, v160, v235
    v_add_f32 v161, v161, v235
    v_add_f32 v162, v162, v235
    v_add_f32 v163, v163, v235
    s_cmp_eq_u32 s80, 0
    s_cbranch_scc1 attn_kernel_n140
    v_sub_f32 v212, 0, v236
    v_sub_f32 v213, 0, v236
    v_sub_f32 v214, 0, v236
    v_sub_f32 v215, 0, v236
    v_sub_f32 v216, 0, v236
    v_sub_f32 v217, 0, v236
    v_sub_f32 v218, 0, v236
    v_sub_f32 v219, 0, v236
    v_sub_f32 v220, 0, v236
    v_sub_f32 v221, 0, v236
    v_sub_f32 v222, 0, v236
    v_sub_f32 v223, 0, v236
    v_sub_f32 v224, 0, v236
    v_sub_f32 v225, 0, v236
    v_sub_f32 v226, 0, v236
    v_sub_f32 v227, 0, v236
    attn_kernel_n140:
    s_cmp_eq_u64 s[52:53], 0
    s_cbranch_scc1 attn_kernel_nr39
    v_mul_f32 v4, v4, v237
    v_mul_f32 v5, v5, v237
    v_mul_f32 v6, v6, v237
    v_mul_f32 v7, v7, v237
    v_mul_f32 v8, v8, v237
    v_mul_f32 v9, v9, v237
    v_mul_f32 v10, v10, v237
    v_mul_f32 v11, v11, v237
    v_mul_f32 v12, v12, v237
    v_mul_f32 v13, v13, v237
    v_mul_f32 v14, v14, v237
    v_mul_f32 v15, v15, v237
    v_mul_f32 v16, v16, v237
    v_mul_f32 v17, v17, v237
    v_mul_f32 v18, v18, v237
    v_mul_f32 v19, v19, v237
    v_mul_f32 v20, v20, v237
    v_mul_f32 v21, v21, v237
    v_mul_f32 v22, v22, v237
    v_mul_f32 v23, v23, v237
    v_mul_f32 v24, v24, v237
    v_mul_f32 v25, v25, v237
    v_mul_f32 v26, v26, v237
    v_mul_f32 v27, v27, v237
    v_mul_f32 v28, v28, v237
    v_mul_f32 v29, v29, v237
    v_mul_f32 v30, v30, v237
    v_mul_f32 v31, v31, v237
    v_mul_f32 v32, v32, v237
    v_mul_f32 v33, v33, v237
    v_mul_f32 v34, v34, v237
    v_mul_f32 v35, v35, v237
    v_mul_f32 v36, v36, v237
    v_mul_f32 v37, v37, v237
    v_mul_f32 v38, v38, v237
    v_mul_f32 v39, v39, v237
    v_mul_f32 v40, v40, v237
    v_mul_f32 v41, v41, v237
    v_mul_f32 v42, v42, v237
    v_mul_f32 v43, v43, v237
    v_mul_f32 v44, v44, v237
    v_mul_f32 v45, v45, v237
    v_mul_f32 v46, v46, v237
    v_mul_f32 v47, v47, v237
    v_mul_f32 v48, v48, v237
    v_mul_f32 v49, v49, v237
    v_mul_f32 v50, v50, v237
    v_mul_f32 v51, v51, v237
    v_mul_f32 v52, v52, v237
    v_mul_f32 v53, v53, v237
    v_mul_f32 v54, v54, v237
    v_mul_f32 v55, v55, v237
    v_mul_f32 v56, v56, v237
    v_mul_f32 v57, v57, v237
    v_mul_f32 v58, v58, v237
    v_mul_f32 v59, v59, v237
    v_mul_f32 v60, v60, v237
    v_mul_f32 v61, v61, v237
    v_mul_f32 v62, v62, v237
    v_mul_f32 v63, v63, v237
    v_mul_f32 v64, v64, v237
    v_mul_f32 v65, v65, v237
    v_mul_f32 v66, v66, v237
    v_mul_f32 v67, v67, v237
    v_mul_f32 v233, v233, v237
    v_mul_f32 v243, v243, v237
attn_kernel_nr39:
    v_exp_f32 v132, v132
    s_waitcnt lgkmcnt(7)
    v_mfma_f32_32x32x16_bf16 v[100:115], v[196:199], v[92:95], v[100:115]
    ds_read_b128 v[196:199], v230 offset:33792
    s_cmp_ge_u32 s51, 17
    s_cbranch_scc1 attn_kernel_dv43
    s_add_u32 s36, s45, 0x4000
    s_add_u32 m0, s31, 0x14000
    s_nop 0
    buffer_load_dwordx4 v240, s[12:15], s36 offen lds
attn_kernel_dv43:
    v_exp_f32 v133, v133
    v_exp_f32 v134, v134
    v_exp_f32 v135, v135
    s_waitcnt lgkmcnt(7)
    v_mfma_f32_32x32x16_bf16 v[116:131], v[200:203], v[92:95], v[116:131]
    ds_read_b128 v[200:203], v230 offset:41984
    v_exp_f32 v136, v136
    v_exp_f32 v137, v137
    v_exp_f32 v138, v138
    s_waitcnt lgkmcnt(7)
    v_mfma_f32_32x32x16_bf16 v[100:115], v[204:207], v[96:99], v[100:115]
    ds_read_b128 v[204:207], v230 offset:50176
    s_cmp_ge_u32 s51, 17
    s_cbranch_scc1 attn_kernel_dv44
    s_add_u32 s36, s45, 0x6000
    s_add_u32 m0, s31, 0x16000
    s_nop 0
    buffer_load_dwordx4 v240, s[12:15], s36 offen lds
    s_add_u32 s45, s45, 0x8000
    s_add_u32 s51, s51, 1
    s_cmp_eq_u32 s51, s41
    s_cselect_b32 s45, 0, s45
attn_kernel_dv44:
    v_exp_f32 v139, v139
    v_cvt_pk_bf16_f32 v164, v132, v133
    v_cvt_pk_bf16_f32 v165, v134, v135
    v_cvt_pk_bf16_f32 v166, v136, v137
    v_cvt_pk_bf16_f32 v167, v138, v139
    s_waitcnt lgkmcnt(7)
    v_mfma_f32_32x32x16_bf16 v[116:131], v[208:211], v[96:99], v[116:131]
    ds_read_b128 v[208:211], v230 offset:58368
    v_add_f32 v233, v233, v132
    v_add_f32 v243, v243, v133
    v_add_f32 v233, v233, v134
    v_add_f32 v243, v243, v135
    v_add_f32 v233, v233, v136
    v_add_f32 v243, v243, v137
    v_add_f32 v233, v233, v138
    s_nop 1
    s_waitcnt lgkmcnt(7)
    v_mfma_f32_32x32x16_bf16 v[4:19], v[180:183], v[164:167], v[4:19]
    ds_read_b128 v[180:183], v230 offset:34816
    s_cmp_ge_u32 s50, 17
    s_cbranch_scc1 attn_kernel_dk45
    s_add_u32 s36, s44, 0x0
    s_add_u32 m0, s31, 0x0
    s_nop 0
    buffer_load_dwordx4 v240, s[24:27], s36 offen lds
attn_kernel_dk45:
    v_add_f32 v243, v243, v139
    v_exp_f32 v140, v140
    v_exp_f32 v141, v141
    v_exp_f32 v142, v142
    s_waitcnt lgkmcnt(7)
    v_mfma_f32_32x32x16_bf16 v[20:35], v[184:187], v[164:167], v[20:35]
    ds_read_b128 v[184:187], v230 offset:43008
    v_exp_f32 v143, v143
    v_exp_f32 v144, v144
    v_exp_f32 v145, v145
    s_waitcnt lgkmcnt(7)
    v_mfma_f32_32x32x16_bf16 v[36:51], v[188:191], v[164:167], v[36:51]
    ds_read_b128 v[188:191], v230 offset:51200
    s_cmp_ge_u32 s50, 17
    s_cbranch_scc1 attn_kernel_dk46
    s_add_u32 s36, s44, 0x2000
    s_add_u32 m0, s31, 0x2000
    s_nop 0
    buffer_load_dwordx4 v240, s[24:27], s36 offen lds
attn_kernel_dk46:
    v_exp_f32 v146, v146
    v_exp_f32 v147, v147
    v_cvt_pk_bf16_f32 v168, v140, v141
    s_waitcnt lgkmcnt(7)
    v_mfma_f32_32x32x16_bf16 v[52:67], v[192:195], v[164:167], v[52:67]
    ds_read_b128 v[192:195], v230 offset:59392
    v_cvt_pk_bf16_f32 v169, v142, v143
    v_cvt_pk_bf16_f32 v170, v144, v145
    v_cvt_pk_bf16_f32 v171, v146, v147
    v_add_f32 v233, v233, v140
    v_add_f32 v243, v243, v141
    v_add_f32 v233, v233, v142
    s_nop 1
    s_waitcnt lgkmcnt(7)
    v_mfma_f32_32x32x16_bf16 v[4:19], v[196:199], v[168:171], v[4:19]
    ds_read_b128 v[196:199], v230 offset:35840
    s_cmp_ge_u32 s50, 17
    s_cbranch_scc1 attn_kernel_dk47
    s_add_u32 s36, s44, 0x4000
    s_add_u32 m0, s31, 0x4000
    s_nop 0
    buffer_load_dwordx4 v240, s[24:27], s36 offen lds
attn_kernel_dk47:
    v_add_f32 v243, v243, v143
    v_add_f32 v233, v233, v144
    v_add_f32 v243, v243, v145
    v_add_f32 v233, v233, v146
    v_add_f32 v243, v243, v147
    s_waitcnt lgkmcnt(7)
    v_mfma_f32_32x32x16_bf16 v[20:35], v[200:203], v[168:171], v[20:35]
    ds_read_b128 v[200:203], v230 offset:44032
    v_exp_f32 v148, v148
    v_exp_f32 v149, v149
    v_exp_f32 v150, v150
    v_exp_f32 v151, v151
    s_waitcnt lgkmcnt(7)
    v_mfma_f32_32x32x16_bf16 v[36:51], v[204:207], v[168:171], v[36:51]
    ds_read_b128 v[204:207], v230 offset:52224
    s_cmp_ge_u32 s50, 17
    s_cbranch_scc1 attn_kernel_dk48
    s_add_u32 s36, s44, 0x6000
    s_add_u32 m0, s31, 0x6000
    s_nop 0
    buffer_load_dwordx4 v240, s[24:27], s36 offen lds
    s_add_u32 s44, s44, 0x8000
    s_add_u32 s50, s50, 1
    s_cmp_eq_u32 s50, s41
    s_cselect_b32 s44, 0, s44
attn_kernel_dk48:
    v_exp_f32 v152, v152
    v_exp_f32 v153, v153
    v_exp_f32 v154, v154
    v_exp_f32 v155, v155
    s_waitcnt lgkmcnt(7)
    v_mfma_f32_32x32x16_bf16 v[52:67], v[208:211], v[168:171], v[52:67]
    ds_read_b128 v[208:211], v230 offset:60416
    s_cmp_lg_u32 s42, 15
    s_cbranch_scc1 attn_kernel_wp49
    v_lshlrev_b32 v244, 4, v0
    buffer_load_dwordx4 v[248:251], v244, s[60:63], 0 offen
    buffer_load_dwordx4 v[248:251], v244, s[64:67], 0 offen
    buffer_load_dwordx4 v[248:251], v244, s[68:71], 0 offen
    buffer_load_dwordx4 v[248:251], v244, s[72:75], 0 offen
    buffer_load_dwordx4 v[248:251], v244, s[76:79], 0 offen
attn_kernel_wp49:
    v_cvt_pk_bf16_f32 v172, v148, v149
    v_cvt_pk_bf16_f32 v173, v150, v151
    v_cvt_pk_bf16_f32 v174, v152, v153
    v_cvt_pk_bf16_f32 v175, v154, v155
    s_nop 1
    s_waitcnt lgkmcnt(7)
    v_mfma_f32_32x32x16_bf16 v[4:19], v[180:183], v[172:175], v[4:19]
    ds_read_b128 v[180:183], v228 offset:32768
    v_add_f32 v233, v233, v148
    v_add_f32 v243, v243, v149
    v_add_f32 v233, v233, v150
    v_add_f32 v243, v243, v151
    v_add_f32 v233, v233, v152
    s_waitcnt lgkmcnt(7)
    v_mfma_f32_32x32x16_bf16 v[20:35], v[184:187], v[172:175], v[20:35]
    ds_read_b128 v[184:187], v228 offset:40960
    v_add_f32 v243, v243, v153
    v_add_f32 v233, v233, v154
    v_add_f32 v243, v243, v155
    v_exp_f32 v156, v156
    v_exp_f32 v157, v157
    s_waitcnt lgkmcnt(7)
    v_mfma_f32_32x32x16_bf16 v[36:51], v[188:191], v[172:175], v[36:51]
    ds_read_b128 v[188:191], v228 offset:33792
    v_exp_f32 v158, v158
    v_exp_f32 v159, v159
    v_exp_f32 v160, v160
    v_exp_f32 v161, v161
    v_exp_f32 v162, v162
    s_waitcnt lgkmcnt(7)
    v_mfma_f32_32x32x16_bf16 v[52:67], v[192:195], v[172:175], v[52:67]
    ds_read_b128 v[192:195], v228 offset:41984
    v_exp_f32 v163, v163
    v_cvt_pk_bf16_f32 v176, v156, v157
    v_cvt_pk_bf16_f32 v177, v158, v159
    v_cvt_pk_bf16_f32 v178, v160, v161
    v_cvt_pk_bf16_f32 v179, v162, v163
    s_nop 1
    s_waitcnt lgkmcnt(7)
    v_mfma_f32_32x32x16_bf16 v[4:19], v[196:199], v[176:179], v[4:19]
    ds_read_b128 v[196:199], v228 offset:34816
    v_add_f32 v233, v233, v156
    v_add_f32 v243, v243, v157
    v_add_f32 v233, v233, v158
    s_waitcnt lgkmcnt(7)
    v_mfma_f32_32x32x16_bf16 v[20:35], v[200:203], v[176:179], v[20:35]
    ds_read_b128 v[200:203], v228 offset:43008
    v_add_f32 v243, v243, v159
    v_add_f32 v233, v233, v160
    v_add_f32 v243, v243, v161
    v_add_f32 v233, v233, v162
    v_add_f32 v243, v243, v163
    s_waitcnt lgkmcnt(7)
    v_mfma_f32_32x32x16_bf16 v[36:51], v[204:207], v[176:179], v[36:51]
    ds_read_b128 v[204:207], v228 offset:35840
    s_waitcnt lgkmcnt(7)
    v_mfma_f32_32x32x16_bf16 v[52:67], v[208:211], v[176:179], v[52:67]
    ds_read_b128 v[208:211], v228 offset:44032
    s_mov_b32 s38, 0x18000
attn_kernel_fin:
    v_add_f32 v233, v233, v243
    v_mov_b32 v235, v233
    s_nop 1
    v_permlane32_swap_b32 v235, v233
    v_add_f32 v233, v233, v235
    s_lshl_b32 s35, s28, 9
    s_add_u32 s35, s35, 0x20000
    v_lshl_add_u32 v245, v241, 3, s35
    s_xor_b32 s35, s35, 0x800
    v_lshl_add_u32 v235, v241, 3, s35
    ds_write_b64 v245, v[232:233]
    s_lshl_b32 s35, s34, 13
    s_add_u32 s36, s35, s38
    s_add_u32 s35, s35, 0x20000
    s_cmp_eq_u32 s33, 0
    s_cselect_b32 s37, s36, s35
    s_cselect_b32 s35, s35, s36
    v_lshl_add_u32 v244, v241, 4, s37
    v_lshl_add_u32 v246, v241, 4, s35
    s_waitcnt lgkmcnt(0)
    s_barrier
    ds_read_b64 v[234:235], v235
    s_cmp_eq_u32 s33, 0
    s_cbranch_scc0 attn_kernel_fin1
    ds_write_b128 v244, v[36:39] offset:0
    ds_write_b128 v244, v[40:43] offset:1024
    ds_write_b128 v244, v[44:47] offset:2048
    ds_write_b128 v244, v[48:51] offset:3072
    ds_write_b128 v244, v[52:55] offset:4096
    ds_write_b128 v244, v[56:59] offset:5120
    ds_write_b128 v244, v[60:63] offset:6144
    ds_write_b128 v244, v[64:67] offset:7168
    s_waitcnt lgkmcnt(0)
    s_barrier
    v_max_f32 v236, v232, v234
    v_sub_f32 v232, v232, v236
    v_sub_f32 v234, v234, v236
    v_exp_f32 v232, v232
    v_exp_f32 v234, v234
    s_nop 0
    v_mul_f32 v233, v233, v232
    v_fmac_f32 v233, v235, v234
    v_rcp_f32 v233, v233
    s_nop 0
    v_mul_f32 v232, v232, v233
    v_mul_f32 v234, v234, v233
    v_mul_f32 v4, v4, v232
    v_mul_f32 v5, v5, v232
    v_mul_f32 v6, v6, v232
    v_mul_f32 v7, v7, v232
    v_mul_f32 v8, v8, v232
    v_mul_f32 v9, v9, v232
    v_mul_f32 v10, v10, v232
    v_mul_f32 v11, v11, v232
    v_mul_f32 v12, v12, v232
    v_mul_f32 v13, v13, v232
    v_mul_f32 v14, v14, v232
    v_mul_f32 v15, v15, v232
    v_mul_f32 v16, v16, v232
    v_mul_f32 v17, v17, v232
    v_mul_f32 v18, v18, v232
    v_mul_f32 v19, v19, v232
    v_mul_f32 v20, v20, v232
    v_mul_f32 v21, v21, v232
    v_mul_f32 v22, v22, v232
    v_mul_f32 v23, v23, v232
    v_mul_f32 v24, v24, v232
    v_mul_f32 v25, v25, v232
    v_mul_f32 v26, v26, v232
    v_mul_f32 v27, v27, v232
    v_mul_f32 v28, v28, v232
    v_mul_f32 v29, v29, v232
    v_mul_f32 v30, v30, v232
    v_mul_f32 v31, v31, v232
    v_mul_f32 v32, v32, v232
    v_mul_f32 v33, v33, v232
    v_mul_f32 v34, v34, v232
    v_mul_f32 v35, v35, v232
    s_waitcnt lgkmcnt(0)
    s_barrier
    ds_read_b128 v[36:39], v246 offset:0
    ds_read_b128 v[40:43], v246 offset:1024
    ds_read_b128 v[44:47], v246 offset:2048
    ds_read_b128 v[48:51], v246 offset:3072
    ds_read_b128 v[52:55], v246 offset:4096
    ds_read_b128 v[56:59], v246 offset:5120
    ds_read_b128 v[60:63], v246 offset:6144
    ds_read_b128 v[64:67], v246 offset:7168
    s_waitcnt lgkmcnt(6)
    v_fmac_f32 v4, v36, v234
    v_fmac_f32 v5, v37, v234
    v_fmac_f32 v6, v38, v234
    v_fmac_f32 v7, v39, v234
    v_fmac_f32 v8, v40, v234
    v_fmac_f32 v9, v41, v234
    v_fmac_f32 v10, v42, v234
    v_fmac_f32 v11, v43, v234
    v_cvt_pk_bf16_f32 v164, v4, v5
    v_cvt_pk_bf16_f32 v165, v6, v7
    v_cvt_pk_bf16_f32 v166, v8, v9
    v_cvt_pk_bf16_f32 v167, v10, v11
    buffer_store_dwordx4 v[164:167], v242, s[16:19], s49 offen offset:0 sc1
    s_waitcnt lgkmcnt(4)
    v_fmac_f32 v12, v44, v234
    v_fmac_f32 v13, v45, v234
    v_fmac_f32 v14, v46, v234
    v_fmac_f32 v15, v47, v234
    v_fmac_f32 v16, v48, v234
    v_fmac_f32 v17, v49, v234
    v_fmac_f32 v18, v50, v234
    v_fmac_f32 v19, v51, v234
    v_cvt_pk_bf16_f32 v168, v12, v13
    v_cvt_pk_bf16_f32 v169, v14, v15
    v_cvt_pk_bf16_f32 v170, v16, v17
    v_cvt_pk_bf16_f32 v171, v18, v19
    buffer_store_dwordx4 v[168:171], v242, s[16:19], s49 offen offset:1024 sc1
    s_waitcnt lgkmcnt(2)
    v_fmac_f32 v20, v52, v234
    v_fmac_f32 v21, v53, v234
    v_fmac_f32 v22, v54, v234
    v_fmac_f32 v23, v55, v234
    v_fmac_f32 v24, v56, v234
    v_fmac_f32 v25, v57, v234
    v_fmac_f32 v26, v58, v234
    v_fmac_f32 v27, v59, v234
    v_cvt_pk_bf16_f32 v172, v20, v21
    v_cvt_pk_bf16_f32 v173, v22, v23
    v_cvt_pk_bf16_f32 v174, v24, v25
    v_cvt_pk_bf16_f32 v175, v26, v27
    buffer_store_dwordx4 v[172:175], v242, s[16:19], s49 offen offset:2048 sc1
    s_waitcnt lgkmcnt(0)
    v_fmac_f32 v28, v60, v234
    v_fmac_f32 v29, v61, v234
    v_fmac_f32 v30, v62, v234
    v_fmac_f32 v31, v63, v234
    v_fmac_f32 v32, v64, v234
    v_fmac_f32 v33, v65, v234
    v_fmac_f32 v34, v66, v234
    v_fmac_f32 v35, v67, v234
    v_cvt_pk_bf16_f32 v176, v28, v29
    v_cvt_pk_bf16_f32 v177, v30, v31
    v_cvt_pk_bf16_f32 v178, v32, v33
    v_cvt_pk_bf16_f32 v179, v34, v35
    buffer_store_dwordx4 v[176:179], v242, s[16:19], s49 offen offset:3072 sc1
    s_branch attn_kernel_fin2
attn_kernel_fin1:
    s_waitcnt lgkmcnt(0)
    s_barrier
    ds_write_b128 v244, v[4:7] offset:0
    ds_write_b128 v244, v[8:11] offset:1024
    ds_write_b128 v244, v[12:15] offset:2048
    ds_write_b128 v244, v[16:19] offset:3072
    ds_write_b128 v244, v[20:23] offset:4096
    ds_write_b128 v244, v[24:27] offset:5120
    ds_write_b128 v244, v[28:31] offset:6144
    ds_write_b128 v244, v[32:35] offset:7168
    v_max_f32 v236, v232, v234
    v_sub_f32 v232, v232, v236
    v_sub_f32 v234, v234, v236
    v_exp_f32 v232, v232
    v_exp_f32 v234, v234
    s_nop 0
    v_mul_f32 v233, v233, v232
    v_fmac_f32 v233, v235, v234
    v_rcp_f32 v233, v233
    s_nop 0
    v_mul_f32 v232, v232, v233
    v_mul_f32 v234, v234, v233
    v_mul_f32 v36, v36, v232
    v_mul_f32 v37, v37, v232
    v_mul_f32 v38, v38, v232
    v_mul_f32 v39, v39, v232
    v_mul_f32 v40, v40, v232
    v_mul_f32 v41, v41, v232
    v_mul_f32 v42, v42, v232
    v_mul_f32 v43, v43, v232
    v_mul_f32 v44, v44, v232
    v_mul_f32 v45, v45, v232
    v_mul_f32 v46, v46, v232
    v_mul_f32 v47, v47, v232
    v_mul_f32 v48, v48, v232
    v_mul_f32 v49, v49, v232
    v_mul_f32 v50, v50, v232
    v_mul_f32 v51, v51, v232
    v_mul_f32 v52, v52, v232
    v_mul_f32 v53, v53, v232
    v_mul_f32 v54, v54, v232
    v_mul_f32 v55, v55, v232
    v_mul_f32 v56, v56, v232
    v_mul_f32 v57, v57, v232
    v_mul_f32 v58, v58, v232
    v_mul_f32 v59, v59, v232
    v_mul_f32 v60, v60, v232
    v_mul_f32 v61, v61, v232
    v_mul_f32 v62, v62, v232
    v_mul_f32 v63, v63, v232
    v_mul_f32 v64, v64, v232
    v_mul_f32 v65, v65, v232
    v_mul_f32 v66, v66, v232
    v_mul_f32 v67, v67, v232
    s_waitcnt lgkmcnt(0)
    s_barrier
    ds_read_b128 v[4:7], v246 offset:0
    ds_read_b128 v[8:11], v246 offset:1024
    ds_read_b128 v[12:15], v246 offset:2048
    ds_read_b128 v[16:19], v246 offset:3072
    ds_read_b128 v[20:23], v246 offset:4096
    ds_read_b128 v[24:27], v246 offset:5120
    ds_read_b128 v[28:31], v246 offset:6144
    ds_read_b128 v[32:35], v246 offset:7168
    s_waitcnt lgkmcnt(6)
    v_fmac_f32 v36, v4, v234
    v_fmac_f32 v37, v5, v234
    v_fmac_f32 v38, v6, v234
    v_fmac_f32 v39, v7, v234
    v_fmac_f32 v40, v8, v234
    v_fmac_f32 v41, v9, v234
    v_fmac_f32 v42, v10, v234
    v_fmac_f32 v43, v11, v234
    v_cvt_pk_bf16_f32 v164, v36, v37
    v_cvt_pk_bf16_f32 v165, v38, v39
    v_cvt_pk_bf16_f32 v166, v40, v41
    v_cvt_pk_bf16_f32 v167, v42, v43
    buffer_store_dwordx4 v[164:167], v242, s[16:19], s49 offen offset:0 sc1
    s_waitcnt lgkmcnt(4)
    v_fmac_f32 v44, v12, v234
    v_fmac_f32 v45, v13, v234
    v_fmac_f32 v46, v14, v234
    v_fmac_f32 v47, v15, v234
    v_fmac_f32 v48, v16, v234
    v_fmac_f32 v49, v17, v234
    v_fmac_f32 v50, v18, v234
    v_fmac_f32 v51, v19, v234
    v_cvt_pk_bf16_f32 v168, v44, v45
    v_cvt_pk_bf16_f32 v169, v46, v47
    v_cvt_pk_bf16_f32 v170, v48, v49
    v_cvt_pk_bf16_f32 v171, v50, v51
    buffer_store_dwordx4 v[168:171], v242, s[16:19], s49 offen offset:1024 sc1
    s_waitcnt lgkmcnt(2)
    v_fmac_f32 v52, v20, v234
    v_fmac_f32 v53, v21, v234
    v_fmac_f32 v54, v22, v234
    v_fmac_f32 v55, v23, v234
    v_fmac_f32 v56, v24, v234
    v_fmac_f32 v57, v25, v234
    v_fmac_f32 v58, v26, v234
    v_fmac_f32 v59, v27, v234
    v_cvt_pk_bf16_f32 v172, v52, v53
    v_cvt_pk_bf16_f32 v173, v54, v55
    v_cvt_pk_bf16_f32 v174, v56, v57
    v_cvt_pk_bf16_f32 v175, v58, v59
    buffer_store_dwordx4 v[172:175], v242, s[16:19], s49 offen offset:2048 sc1
    s_waitcnt lgkmcnt(0)
    v_fmac_f32 v60, v28, v234
    v_fmac_f32 v61, v29, v234
    v_fmac_f32 v62, v30, v234
    v_fmac_f32 v63, v31, v234
    v_fmac_f32 v64, v32, v234
    v_fmac_f32 v65, v33, v234
    v_fmac_f32 v66, v34, v234
    v_fmac_f32 v67, v35, v234
    v_cvt_pk_bf16_f32 v176, v60, v61
    v_cvt_pk_bf16_f32 v177, v62, v63
    v_cvt_pk_bf16_f32 v178, v64, v65
    v_cvt_pk_bf16_f32 v179, v66, v67
    buffer_store_dwordx4 v[176:179], v242, s[16:19], s49 offen offset:3072 sc1
attn_kernel_fin2:
    s_cmp_eq_u32 s42, 16
    s_cbranch_scc1 attn_kernel_done
    s_add_u32 s42, s42, 1
    s_mov_b32 s43, 16
    s_mov_b32 s49, s47
    v_mov_b32 v4, 0
    v_mov_b32 v5, 0
    v_mov_b32 v6, 0
    v_mov_b32 v7, 0
    v_mov_b32 v8, 0
    v_mov_b32 v9, 0
    v_mov_b32 v10, 0
    v_mov_b32 v11, 0
    v_mov_b32 v12, 0
    v_mov_b32 v13, 0
    v_mov_b32 v14, 0
    v_mov_b32 v15, 0
    v_mov_b32 v16, 0
    v_mov_b32 v17, 0
    v_mov_b32 v18, 0
    v_mov_b32 v19, 0
    v_mov_b32 v20, 0
    v_mov_b32 v21, 0
    v_mov_b32 v22, 0
    v_mov_b32 v23, 0
    v_mov_b32 v24, 0
    v_mov_b32 v25, 0
    v_mov_b32 v26, 0
    v_mov_b32 v27, 0
    v_mov_b32 v28, 0
    v_mov_b32 v29, 0
    v_mov_b32 v30, 0
    v_mov_b32 v31, 0
    v_mov_b32 v32, 0
    v_mov_b32 v33, 0
    v_mov_b32 v34, 0
    v_mov_b32 v35, 0
    v_mov_b32 v36, 0
    v_mov_b32 v37, 0
    v_mov_b32 v38, 0
    v_mov_b32 v39, 0
    v_mov_b32 v40, 0
    v_mov_b32 v41, 0
    v_mov_b32 v42, 0
    v_mov_b32 v43, 0
    v_mov_b32 v44, 0
    v_mov_b32 v45, 0
    v_mov_b32 v46, 0
    v_mov_b32 v47, 0
    v_mov_b32 v48, 0
    v_mov_b32 v49, 0
    v_mov_b32 v50, 0
    v_mov_b32 v51, 0
    v_mov_b32 v52, 0
    v_mov_b32 v53, 0
    v_mov_b32 v54, 0
    v_mov_b32 v55, 0
    v_mov_b32 v56, 0
    v_mov_b32 v57, 0
    v_mov_b32 v58, 0
    v_mov_b32 v59, 0
    v_mov_b32 v60, 0
    v_mov_b32 v61, 0
    v_mov_b32 v62, 0
    v_mov_b32 v63, 0
    v_mov_b32 v64, 0
    v_mov_b32 v65, 0
    v_mov_b32 v66, 0
    v_mov_b32 v67, 0
    v_mov_b32 v232, 0xf149f2ca
    v_mov_b32 v233, 0
    v_mov_b32 v243, 0
    v_mov_b32 v247, 0
    s_mov_b32 s80, 1
    s_cmp_eq_u32 s38, 0x10000
    s_cbranch_scc1 attn_kernel_loop1
    s_branch attn_kernel_loop0
attn_kernel_done:
    s_waitcnt vmcnt(0)
attn_kernel_end:
    s_endpgm
.text
.globl oproj_kernel
.p2align 8
.type oproj_kernel,@function
oproj_kernel:
    s_cmp_ge_u32 s2, 256
    s_cbranch_scc1 oproj_kernel_end
    s_load_dwordx2 s[46:47], s[0:1], 40
    s_load_dwordx2 s[50:51], s[0:1], 112
    s_waitcnt lgkmcnt(0)
    s_and_b32 s40, s2, 1
    s_lshl_b32 s40, s40, 3
    s_bfe_u32 s35, s2, 0x30003
    s_add_u32 s40, s40, s35
    s_lshl_b32 s40, s40, 7
    s_lshr_b32 s41, s2, 6
    s_lshl_b32 s41, s41, 7
    s_mov_b32 s42, s41
    s_bfe_u32 s35, s2, 0x20001
    s_lshl_b32 s43, s35, 10
    s_lshl_b32 s35, s35, 21
    s_add_u32 s4, s50, 0x3400000
    s_addc_u32 s5, s51, 0
    s_mov_b32 s6, 0x1000000
    s_mov_b32 s7, 0x00020000
    s_mov_b32 s8, s46
    s_mov_b32 s9, s47
    s_mov_b32 s10, 0x400000
    s_mov_b32 s11, 0x00020000
    s_add_u32 s16, s50, 0x5000000
    s_addc_u32 s17, s51, 0
    s_mov_b32 s18, 0x200000
    s_mov_b32 s19, 0x00020000
    s_add_u32 s16, s16, s35
    s_addc_u32 s17, s17, 0
    v_lshrrev_b32 v1, 6, v0
    v_and_b32 v68, 63, v0
    s_nop 0
    v_readfirstlane_b32 s28, v1
    s_lshl_b32 s31, s28, 10
    s_lshr_b32 s33, s28, 3
    s_and_b32 s34, s28, 7
    s_and_b32 s35, s34, 1
    s_lshr_b32 s36, s34, 1
    s_lshr_b32 s37, s28, 3
    s_lshr_b32 s38, s40, 5
    s_add_u32 s37, s37, s38
    s_mul_i32 s37, s37, 262144
    s_and_b32 s38, s28, 7
    s_lshl_b32 s38, s38, 10
    s_add_u32 s37, s37, s38
    v_lshl_add_u32 v60, v68, 4, s37
    v_add_u32 v61, 0x40000, v60
    v_add_u32 v62, 0x80000, v60
    v_add_u32 v63, 0xc0000, v60
    v_lshrrev_b32 v69, 4, v68
    s_mul_i32 s37, s28, 4
    v_add_u32 v69, s37, v69
    v_and_b32 v70, 15, v68
    v_and_b32 v71, 3, v69
    v_lshlrev_b32 v71, 2, v71
    v_xor_b32 v70, v70, v71
    v_lshlrev_b32 v70, 4, v70
    s_mov_b32 s37, 1024
    v_mul_lo_u32 v69, v69, s37
    s_lshl_b32 s37, s41, 1
    v_add3_u32 v64, v69, v70, s37
    v_add_u32 v65, 0x8000, v64
    v_add_u32 v66, 0x10000, v64
    v_add_u32 v67, 0x18000, v64
    s_lshr_b32 s49, s2, 3
    s_and_b32 s49, s49, 1
    s_mul_i32 s49, s49, 4
    s_mul_i32 s30, s49, 128
    s_add_u32 s30, s30, s43
    s_lshl_b32 s29, s30, 6
    s_mul_i32 s30, s30, 1024
    s_add_u32 s44, s31, 0x0
    s_add_u32 m0, s44, 0x0
    s_nop 0
    buffer_load_dwordx4 v60, s[4:7], s29 offen lds
    s_add_u32 m0, s44, 0x2000
    s_nop 0
    buffer_load_dwordx4 v61, s[4:7], s29 offen lds
    s_add_u32 m0, s44, 0x4000
    s_nop 0
    buffer_load_dwordx4 v62, s[4:7], s29 offen lds
    s_add_u32 m0, s44, 0x6000
    s_nop 0
    buffer_load_dwordx4 v63, s[4:7], s29 offen lds
    s_add_u32 m0, s44, 0x8000
    s_nop 0
    buffer_load_dwordx4 v64, s[8:11], s30 offen lds
    s_add_u32 m0, s44, 0xa000
    s_nop 0
    buffer_load_dwordx4 v65, s[8:11], s30 offen lds
    s_add_u32 m0, s44, 0xc000
    s_nop 0
    buffer_load_dwordx4 v66, s[8:11], s30 offen lds
    s_add_u32 m0, s44, 0xe000
    s_nop 0
    buffer_load_dwordx4 v67, s[8:11], s30 offen lds
    s_add_u32 s49, s49, 1
    s_cmp_ge_u32 s49, 8
    s_cselect_b32 s49, 0, s49
    s_mul_i32 s30, s49, 128
    s_add_u32 s30, s30, s43
    s_lshl_b32 s29, s30, 6
    s_mul_i32 s30, s30, 1024
    s_add_u32 s44, s31, 0x10000
    s_add_u32 m0, s44, 0x0
    s_nop 0
    buffer_load_dwordx4 v60, s[4:7], s29 offen lds
    s_add_u32 m0, s44, 0x2000
    s_nop 0
    buffer_load_dwordx4 v61, s[4:7], s29 offen lds
    s_add_u32 m0, s44, 0x4000
    s_nop 0
    buffer_load_dwordx4 v62, s[4:7], s29 offen lds
    s_add_u32 m0, s44, 0x6000
    s_nop 0
    buffer_load_dwordx4 v63, s[4:7], s29 offen lds
    s_add_u32 m0, s44, 0x8000
    s_nop 0
    buffer_load_dwordx4 v64, s[8:11], s30 offen lds
    s_add_u32 m0, s44, 0xa000
    s_nop 0
    buffer_load_dwordx4 v65, s[8:11], s30 offen lds
    s_add_u32 m0, s44, 0xc000
    s_nop 0
    buffer_load_dwordx4 v66, s[8:11], s30 offen lds
    s_add_u32 m0, s44, 0xe000
    s_nop 0
    buffer_load_dwordx4 v67, s[8:11], s30 offen lds
    s_add_u32 s49, s49, 1
    s_cmp_ge_u32 s49, 8
    s_cselect_b32 s49, 0, s49
    s_mul_i32 s30, s49, 128
    s_add_u32 s30, s30, s43
    s_lshl_b32 s29, s30, 6
    s_mul_i32 s30, s30, 1024
    s_add_u32 s44, s31, 0x0
    s_mov_b32 s45, 0x0
    s_mov_b32 s48, 0x10000
    s_mul_i32 s37, s35, 16384
    s_mul_i32 s38, s33, 8192
    s_add_u32 s37, s37, s38
    v_lshl_add_u32 v73, v68, 4, s37
    v_bfe_u32 v69, v68, 2, 2
    v_lshrrev_b32 v70, 5, v68
    v_lshlrev_b32 v70, 2, v70
    v_add_u32 v70, v70, v69
    s_mul_i32 s37, s33, 128
    v_add_u32 v70, s37, v70
    v_lshlrev_b32 v70, 8, v70
    v_and_b32 v71, 3, v68
    v_lshlrev_b32 v71, 3, v71
    v_add_u32 v70, v70, v71
    v_bfe_u32 v71, v68, 4, 1
    v_lshlrev_b32 v71, 5, v71
    v_add_u32 v70, v70, v71
    s_mul_i32 s37, s36, 1
    s_add_u32 s38, s37, 0
    v_xor_b32 v71, s38, v69
    v_lshl_add_u32 v71, v71, 6, v70
    v_add_u32 v74, 0x8000, v71
    s_waitcnt vmcnt(8)
    s_barrier
    ds_read_b128 v[36:39], v73 offset:0
    ds_read_b128 v[40:43], v73 offset:8192
    ds_read_b64_tr_b16 v[44:45], v74 offset:0
    ds_read_b64_tr_b16 v[46:47], v74 offset:2048
    ds_read_b128 v[48:51], v73 offset:1024
    ds_read_b128 v[52:55], v73 offset:9216
    ds_read_b64_tr_b16 v[56:57], v74 offset:4096
    ds_read_b64_tr_b16 v[58:59], v74 offset:6144
    s_waitcnt lgkmcnt(4)
    v_mfma_f32_32x32x16_bf16 v[4:19], v[44:47], v[36:39], 0
    v_mfma_f32_32x32x16_bf16 v[20:35], v[44:47], v[40:43], 0
    ds_read_b128 v[36:39], v73 offset:2048
    ds_read_b128 v[40:43], v73 offset:10240
    ds_read_b64_tr_b16 v[44:45], v74 offset:8192
    ds_read_b64_tr_b16 v[46:47], v74 offset:10240
    s_waitcnt lgkmcnt(4)
    v_mfma_f32_32x32x16_bf16 v[4:19], v[56:59], v[48:51], v[4:19]
    v_mfma_f32_32x32x16_bf16 v[20:35], v[56:59], v[52:55], v[20:35]
    ds_read_b128 v[48:51], v73 offset:3072
    ds_read_b128 v[52:55], v73 offset:11264
    ds_read_b64_tr_b16 v[56:57], v74 offset:12288
    ds_read_b64_tr_b16 v[58:59], v74 offset:14336
    s_waitcnt lgkmcnt(4)
    v_mfma_f32_32x32x16_bf16 v[4:19], v[44:47], v[36:39], v[4:19]
    v_mfma_f32_32x32x16_bf16 v[20:35], v[44:47], v[40:43], v[20:35]
    ds_read_b128 v[36:39], v73 offset:4096
    ds_read_b128 v[40:43], v73 offset:12288
    ds_read_b64_tr_b16 v[44:45], v74 offset:16384
    ds_read_b64_tr_b16 v[46:47], v74 offset:18432
    s_waitcnt lgkmcnt(4)
    v_mfma_f32_32x32x16_bf16 v[4:19], v[56:59], v[48:51], v[4:19]
    v_mfma_f32_32x32x16_bf16 v[20:35], v[56:59], v[52:55], v[20:35]
    ds_read_b128 v[48:51], v73 offset:5120
    ds_read_b128 v[52:55], v73 offset:13312
    ds_read_b64_tr_b16 v[56:57], v74 offset:20480
    ds_read_b64_tr_b16 v[58:59], v74 offset:22528
    s_waitcnt lgkmcnt(4)
    v_mfma_f32_32x32x16_bf16 v[4:19], v[44:47], v[36:39], v[4:19]
    v_mfma_f32_32x32x16_bf16 v[20:35], v[44:47], v[40:43], v[20:35]
    ds_read_b128 v[36:39], v73 offset:6144
    ds_read_b128 v[40:43], v73 offset:14336
    ds_read_b64_tr_b16 v[44:45], v74 offset:24576
    ds_read_b64_tr_b16 v[46:47], v74 offset:26624
    s_waitcnt lgkmcnt(4)
    v_mfma_f32_32x32x16_bf16 v[4:19], v[56:59], v[48:51], v[4:19]
    v_mfma_f32_32x32x16_bf16 v[20:35], v[56:59], v[52:55], v[20:35]
    ds_read_b128 v[48:51], v73 offset:7168
    ds_read_b128 v[52:55], v73 offset:15360
    ds_read_b64_tr_b16 v[56:57], v74 offset:28672
    ds_read_b64_tr_b16 v[58:59], v74 offset:30720
    s_waitcnt lgkmcnt(4)
    v_mfma_f32_32x32x16_bf16 v[4:19], v[44:47], v[36:39], v[4:19]
    v_mfma_f32_32x32x16_bf16 v[20:35], v[44:47], v[40:43], v[20:35]
    s_waitcnt lgkmcnt(0)
    v_mfma_f32_32x32x16_bf16 v[4:19], v[56:59], v[48:51], v[4:19]
    s_add_u32 s45, s45, 0x10000
    s_cmp_ge_u32 s45, 0x20000
    s_cselect_b32 s46, 0xffff0000, s48
    s_cselect_b32 s45, 0, s45
    v_add_u32 v73, s46, v73
    v_add_u32 v74, s46, v74
    s_waitcnt vmcnt(0)
    s_barrier
    ds_read_b128 v[36:39], v73 offset:0
    ds_read_b128 v[40:43], v73 offset:8192
    ds_read_b64_tr_b16 v[44:45], v74 offset:0
    ds_read_b64_tr_b16 v[46:47], v74 offset:2048
    v_mfma_f32_32x32x16_bf16 v[20:35], v[56:59], v[52:55], v[20:35]
    s_mov_b32 s47, 6
oproj_kernel_loop:
    ds_read_b128 v[48:51], v73 offset:1024
    ds_read_b128 v[52:55], v73 offset:9216
    ds_read_b64_tr_b16 v[56:57], v74 offset:4096
    ds_read_b64_tr_b16 v[58:59], v74 offset:6144
    s_waitcnt lgkmcnt(4)
    v_mfma_f32_32x32x16_bf16 v[4:19], v[44:47], v[36:39], v[4:19]
    s_add_u32 m0, s44, 0x0
    s_nop 0
    buffer_load_dwordx4 v60, s[4:7], s29 offen lds
    v_mfma_f32_32x32x16_bf16 v[20:35], v[44:47], v[40:43], v[20:35]
    s_add_u32 m0, s44, 0x2000
    s_nop 0
    buffer_load_dwordx4 v61, s[4:7], s29 offen lds
    ds_read_b128 v[36:39], v73 offset:2048
    ds_read_b128 v[40:43], v73 offset:10240
    ds_read_b64_tr_b16 v[44:45], v74 offset:8192
    ds_read_b64_tr_b16 v[46:47], v74 offset:10240
    s_waitcnt lgkmcnt(4)
    v_mfma_f32_32x32x16_bf16 v[4:19], v[56:59], v[48:51], v[4:19]
    s_add_u32 m0, s44, 0x4000
    s_nop 0
    buffer_load_dwordx4 v62, s[4:7], s29 offen lds
    v_mfma_f32_32x32x16_bf16 v[20:35], v[56:59], v[52:55], v[20:35]
    s_add_u32 m0, s44, 0x6000
    s_nop 0
    buffer_load_dwordx4 v63, s[4:7], s29 offen lds
    ds_read_b128 v[48:51], v73 offset:3072
    ds_read_b128 v[52:55], v73 offset:11264
    ds_read_b64_tr_b16 v[56:57], v74 offset:12288
    ds_read_b64_tr_b16 v[58:59], v74 offset:14336
    s_waitcnt lgkmcnt(4)
    v_mfma_f32_32x32x16_bf16 v[4:19], v[44:47], v[36:39], v[4:19]
    s_add_u32 m0, s44, 0x8000
    s_nop 0
    buffer_load_dwordx4 v64, s[8:11], s30 offen lds
    v_mfma_f32_32x32x16_bf16 v[20:35], v[44:47], v[40:43], v[20:35]
    s_add_u32 m0, s44, 0xa000
    s_nop 0
    buffer_load_dwordx4 v65, s[8:11], s30 offen lds
    ds_read_b128 v[36:39], v73 offset:4096
    ds_read_b128 v[40:43], v73 offset:12288
    ds_read_b64_tr_b16 v[44:45], v74 offset:16384
    ds_read_b64_tr_b16 v[46:47], v74 offset:18432
    s_waitcnt lgkmcnt(4)
    v_mfma_f32_32x32x16_bf16 v[4:19], v[56:59], v[48:51], v[4:19]
    s_add_u32 m0, s44, 0xc000
    s_nop 0
    buffer_load_dwordx4 v66, s[8:11], s30 offen lds
    v_mfma_f32_32x32x16_bf16 v[20:35], v[56:59], v[52:55], v[20:35]
    s_add_u32 m0, s44, 0xe000
    s_nop 0
    buffer_load_dwordx4 v67, s[8:11], s30 offen lds
    s_add_u32 s49, s49, 1
    s_cmp_ge_u32 s49, 8
    s_cselect_b32 s49, 0, s49
    s_mul_i32 s30, s49, 128
    s_add_u32 s30, s30, s43
    s_lshl_b32 s29, s30, 6
    s_mul_i32 s30, s30, 1024
    s_add_u32 s44, s44, 0x10000
    s_sub_u32 s46, s44, s31
    s_cmp_ge_u32 s46, 0x20000
    s_cselect_b32 s44, s31, s44
    ds_read_b128 v[48:51], v73 offset:5120
    ds_read_b128 v[52:55], v73 offset:13312
    ds_read_b64_tr_b16 v[56:57], v74 offset:20480
    ds_read_b64_tr_b16 v[58:59], v74 offset:22528
    s_waitcnt lgkmcnt(4)
    v_mfma_f32_32x32x16_bf16 v[4:19], v[44:47], v[36:39], v[4:19]
    v_mfma_f32_32x32x16_bf16 v[20:35], v[44:47], v[40:43], v[20:35]
    ds_read_b128 v[36:39], v73 offset:6144
    ds_read_b128 v[40:43], v73 offset:14336
    ds_read_b64_tr_b16 v[44:45], v74 offset:24576
    ds_read_b64_tr_b16 v[46:47], v74 offset:26624
    s_waitcnt lgkmcnt(4)
    v_mfma_f32_32x32x16_bf16 v[4:19], v[56:59], v[48:51], v[4:19]
    v_mfma_f32_32x32x16_bf16 v[20:35], v[56:59], v[52:55], v[20:35]
    ds_read_b128 v[48:51], v73 offset:7168
    ds_read_b128 v[52:55], v73 offset:15360
    ds_read_b64_tr_b16 v[56:57], v74 offset:28672
    ds_read_b64_tr_b16 v[58:59], v74 offset:30720
    s_waitcnt lgkmcnt(4)
    v_mfma_f32_32x32x16_bf16 v[4:19], v[44:47], v[36:39], v[4:19]
    v_mfma_f32_32x32x16_bf16 v[20:35], v[44:47], v[40:43], v[20:35]
    s_waitcnt lgkmcnt(0)
    v_mfma_f32_32x32x16_bf16 v[4:19], v[56:59], v[48:51], v[4:19]
    s_add_u32 s45, s45, 0x10000
    s_cmp_ge_u32 s45, 0x20000
    s_cselect_b32 s46, 0xffff0000, s48
    s_cselect_b32 s45, 0, s45
    v_add_u32 v73, s46, v73
    v_add_u32 v74, s46, v74
    s_waitcnt vmcnt(0)
    s_barrier
    ds_read_b128 v[36:39], v73 offset:0
    ds_read_b128 v[40:43], v73 offset:8192
    ds_read_b64_tr_b16 v[44:45], v74 offset:0
    ds_read_b64_tr_b16 v[46:47], v74 offset:2048
    v_mfma_f32_32x32x16_bf16 v[20:35], v[56:59], v[52:55], v[20:35]
    s_sub_u32 s47, s47, 1
    s_cmp_lg_u32 s47, 0
    s_cbranch_scc1 oproj_kernel_loop
    ds_read_b128 v[48:51], v73 offset:1024
    ds_read_b128 v[52:55], v73 offset:9216
    ds_read_b64_tr_b16 v[56:57], v74 offset:4096
    ds_read_b64_tr_b16 v[58:59], v74 offset:6144
    s_waitcnt lgkmcnt(4)
    v_mfma_f32_32x32x16_bf16 v[4:19], v[44:47], v[36:39], v[4:19]
    v_mfma_f32_32x32x16_bf16 v[20:35], v[44:47], v[40:43], v[20:35]
    ds_read_b128 v[36:39], v73 offset:2048
    ds_read_b128 v[40:43], v73 offset:10240
    ds_read_b64_tr_b16 v[44:45], v74 offset:8192
    ds_read_b64_tr_b16 v[46:47], v74 offset:10240
    s_waitcnt lgkmcnt(4)
    v_mfma_f32_32x32x16_bf16 v[4:19], v[56:59], v[48:51], v[4:19]
    v_mfma_f32_32x32x16_bf16 v[20:35], v[56:59], v[52:55], v[20:35]
    ds_read_b128 v[48:51], v73 offset:3072
    ds_read_b128 v[52:55], v73 offset:11264
    ds_read_b64_tr_b16 v[56:57], v74 offset:12288
    ds_read_b64_tr_b16 v[58:59], v74 offset:14336
    s_waitcnt lgkmcnt(4)
    v_mfma_f32_32x32x16_bf16 v[4:19], v[44:47], v[36:39], v[4:19]
    v_mfma_f32_32x32x16_bf16 v[20:35], v[44:47], v[40:43], v[20:35]
    ds_read_b128 v[36:39], v73 offset:4096
    ds_read_b128 v[40:43], v73 offset:12288
    ds_read_b64_tr_b16 v[44:45], v74 offset:16384
    ds_read_b64_tr_b16 v[46:47], v74 offset:18432
    s_waitcnt lgkmcnt(4)
    v_mfma_f32_32x32x16_bf16 v[4:19], v[56:59], v[48:51], v[4:19]
    v_mfma_f32_32x32x16_bf16 v[20:35], v[56:59], v[52:55], v[20:35]
    ds_read_b128 v[48:51], v73 offset:5120
    ds_read_b128 v[52:55], v73 offset:13312
    ds_read_b64_tr_b16 v[56:57], v74 offset:20480
    ds_read_b64_tr_b16 v[58:59], v74 offset:22528
    s_waitcnt lgkmcnt(4)
    v_mfma_f32_32x32x16_bf16 v[4:19], v[44:47], v[36:39], v[4:19]
    v_mfma_f32_32x32x16_bf16 v[20:35], v[44:47], v[40:43], v[20:35]
    ds_read_b128 v[36:39], v73 offset:6144
    ds_read_b128 v[40:43], v73 offset:14336
    ds_read_b64_tr_b16 v[44:45], v74 offset:24576
    ds_read_b64_tr_b16 v[46:47], v74 offset:26624
    s_waitcnt lgkmcnt(4)
    v_mfma_f32_32x32x16_bf16 v[4:19], v[56:59], v[48:51], v[4:19]
    v_mfma_f32_32x32x16_bf16 v[20:35], v[56:59], v[52:55], v[20:35]
    ds_read_b128 v[48:51], v73 offset:7168
    ds_read_b128 v[52:55], v73 offset:15360
    ds_read_b64_tr_b16 v[56:57], v74 offset:28672
    ds_read_b64_tr_b16 v[58:59], v74 offset:30720
    s_waitcnt lgkmcnt(4)
    v_mfma_f32_32x32x16_bf16 v[4:19], v[44:47], v[36:39], v[4:19]
    v_mfma_f32_32x32x16_bf16 v[20:35], v[44:47], v[40:43], v[20:35]
    s_waitcnt lgkmcnt(0)
    v_mfma_f32_32x32x16_bf16 v[4:19], v[56:59], v[48:51], v[4:19]
    v_mfma_f32_32x32x16_bf16 v[20:35], v[56:59], v[52:55], v[20:35]
    s_nop 15
    s_nop 3
    v_and_b32 v69, 31, v68
    v_lshrrev_b32 v70, 5, v68
    s_mul_i32 s37, s35, 64
    s_add_u32 s37, s37, s40
    s_mul_i32 s38, s36, 32
    s_add_u32 s38, s38, s42
    s_mov_b32 s39, 2048
    s_lshl_b32 s39, s37, 10
    s_lshl_b32 s38, s38, 6
    s_add_u32 s39, s39, s38
    v_lshl_add_u32 v69, v68, 4, s39
    v_cvt_pk_bf16_f32 v36, v4, v5
    v_cvt_pk_bf16_f32 v37, v6, v7
    v_cvt_pk_bf16_f32 v38, v8, v9
    v_cvt_pk_bf16_f32 v39, v10, v11
    s_mov_b32 s39, 0x0
    buffer_store_dwordx4 v[36:39], v69, s[16:19], s39 offen offset:0 sc1
    v_cvt_pk_bf16_f32 v40, v12, v13
    v_cvt_pk_bf16_f32 v41, v14, v15
    v_cvt_pk_bf16_f32 v42, v16, v17
    v_cvt_pk_bf16_f32 v43, v18, v19
    s_mov_b32 s39, 0x0
    buffer_store_dwordx4 v[40:43], v69, s[16:19], s39 offen offset:1024 sc1
    v_cvt_pk_bf16_f32 v44, v20, v21
    v_cvt_pk_bf16_f32 v45, v22, v23
    v_cvt_pk_bf16_f32 v46, v24, v25
    v_cvt_pk_bf16_f32 v47, v26, v27
    s_mov_b32 s39, 0x8000
    buffer_store_dwordx4 v[44:47], v69, s[16:19], s39 offen offset:0 sc1
    v_cvt_pk_bf16_f32 v48, v28, v29
    v_cvt_pk_bf16_f32 v49, v30, v31
    v_cvt_pk_bf16_f32 v50, v32, v33
    v_cvt_pk_bf16_f32 v51, v34, v35
    s_mov_b32 s39, 0x8000
    buffer_store_dwordx4 v[48:51], v69, s[16:19], s39 offen offset:1024 sc1
    s_endpgm
oproj_kernel_end:
    s_endpgm
.text
.globl ln2_kernel
.p2align 8
.type ln2_kernel,@function
ln2_kernel:
    s_cmp_ge_u32 s2, 256
    s_cbranch_scc1 ln2_kernel_end
    s_load_dwordx2 s[10:11], s[0:1], 112
    s_load_dwordx2 s[8:9], s[0:1], 0
    v_and_b32 v1, 7, v0
    v_bfe_u32 v5, v0, 3, 2
    v_bfe_u32 v6, v0, 5, 1
    v_lshrrev_b32 v7, 6, v0
    v_lshl_add_u32 v5, v7, 2, v5
    v_lshlrev_b32 v3, 4, v1
    v_lshl_add_u32 v3, v6, 9, v3
    v_lshl_add_u32 v3, v5, 10, v3
    v_lshlrev_b32 v2, 1, v5
    v_add_u32 v2, v2, v6
    v_lshlrev_b32 v4, 4, v2
    v_lshl_add_u32 v4, v1, 10, v4
    v_lshlrev_b32 v2, 5, v2
    v_lshlrev_b32 v8, 6, v1
    v_lshl_add_u32 v9, v7, 3, v8
    s_lshr_b32 s35, s2, 2
    s_lshl_b32 s35, s35, 15
    s_and_b32 s36, s2, 3
    s_lshl_b32 s36, s36, 7
    s_add_u32 s35, s35, s36
    s_lshl_b32 s36, s2, 13
    s_waitcnt lgkmcnt(0)
    s_add_u32 s12, s10, 0x5000000
    s_addc_u32 s13, s11, 0
    s_mov_b32 s14, 0x800000
    s_mov_b32 s15, 0x00020000
    s_add_u32 s24, s10, 0x1000
    s_addc_u32 s25, s11, 0
    s_mov_b32 s26, 0x1800
    s_mov_b32 s27, 0x00020000
    s_add_u32 s28, s10, 0x4600000
    s_addc_u32 s29, s11, 0
    s_mov_b32 s30, 0x200000
    s_mov_b32 s31, 0x00020000
    s_add_u32 s16, s10, 0x4400000
    s_addc_u32 s17, s11, 0
    s_mov_b32 s18, 0x200000
    s_mov_b32 s19, 0x00020000
    s_mov_b32 s20, s8
    s_mov_b32 s21, s9
    s_mov_b32 s22, 0x200000
    s_mov_b32 s23, 0x00020000
    s_add_u32 s37, s35, 0x0
    buffer_load_dwordx4 v[32:35], v3, s[12:15], s37 offen
    s_add_u32 s37, s35, 0x200000
    buffer_load_dwordx4 v[36:39], v3, s[12:15], s37 offen
    s_add_u32 s37, s35, 0x400000
    buffer_load_dwordx4 v[40:43], v3, s[12:15], s37 offen
    s_add_u32 s37, s35, 0x600000
    buffer_load_dwordx4 v[44:47], v3, s[12:15], s37 offen
    buffer_load_dwordx4 v[48:51], v4, s[20:23], s36 offen
    s_mov_b32 s37, 0
    buffer_load_dwordx4 v[52:55], v2, s[24:27], s37 offen offset:0
    s_mov_b32 s37, 0
    buffer_load_dwordx4 v[56:59], v2, s[24:27], s37 offen offset:16
    s_mov_b32 s37, 2048
    buffer_load_dwordx4 v[60:63], v2, s[24:27], s37 offen offset:0
    s_mov_b32 s37, 2048
    buffer_load_dwordx4 v[64:67], v2, s[24:27], s37 offen offset:16
    s_mov_b32 s37, 4096
    buffer_load_dwordx4 v[68:71], v2, s[24:27], s37 offen offset:0
    s_mov_b32 s37, 4096
    buffer_load_dwordx4 v[72:75], v2, s[24:27], s37 offen offset:16
    s_waitcnt vmcnt(10)
    v_lshlrev_b32 v16, 16, v32
    v_and_b32 v17, 0xffff0000, v32
    v_lshlrev_b32 v18, 16, v33
    v_and_b32 v19, 0xffff0000, v33
    v_lshlrev_b32 v20, 16, v34
    v_and_b32 v21, 0xffff0000, v34
    v_lshlrev_b32 v22, 16, v35
    v_and_b32 v23, 0xffff0000, v35
    s_waitcnt vmcnt(9)
    v_lshlrev_b32 v24, 16, v36
    v_add_f32 v16, v16, v24
    v_and_b32 v25, 0xffff0000, v36
    v_add_f32 v17, v17, v25
    v_lshlrev_b32 v26, 16, v37
    v_add_f32 v18, v18, v26
    v_and_b32 v27, 0xffff0000, v37
    v_add_f32 v19, v19, v27
    v_lshlrev_b32 v28, 16, v38
    v_add_f32 v20, v20, v28
    v_and_b32 v29, 0xffff0000, v38
    v_add_f32 v21, v21, v29
    v_lshlrev_b32 v30, 16, v39
    v_add_f32 v22, v22, v30
    v_and_b32 v31, 0xffff0000, v39
    v_add_f32 v23, v23, v31
    s_waitcnt vmcnt(8)
    v_lshlrev_b32 v24, 16, v40
    v_add_f32 v16, v16, v24
    v_and_b32 v25, 0xffff0000, v40
    v_add_f32 v17, v17, v25
    v_lshlrev_b32 v26, 16, v41
    v_add_f32 v18, v18, v26
    v_and_b32 v27, 0xffff0000, v41
    v_add_f32 v19, v19, v27
    v_lshlrev_b32 v28, 16, v42
    v_add_f32 v20, v20, v28
    v_and_b32 v29, 0xffff0000, v42
    v_add_f32 v21, v21, v29
    v_lshlrev_b32 v30, 16, v43
    v_add_f32 v22, v22, v30
    v_and_b32 v31, 0xffff0000, v43
    v_add_f32 v23, v23, v31
    s_waitcnt vmcnt(7)
    v_lshlrev_b32 v24, 16, v44
    v_add_f32 v16, v16, v24
    v_and_b32 v25, 0xffff0000, v44
    v_add_f32 v17, v17, v25
    v_lshlrev_b32 v26, 16, v45
    v_add_f32 v18, v18, v26
    v_and_b32 v27, 0xffff0000, v45
    v_add_f32 v19, v19, v27
    v_lshlrev_b32 v28, 16, v46
    v_add_f32 v20, v20, v28
    v_and_b32 v29, 0xffff0000, v46
    v_add_f32 v21, v21, v29
    v_lshlrev_b32 v30, 16, v47
    v_add_f32 v22, v22, v30
    v_and_b32 v31, 0xffff0000, v47
    v_add_f32 v23, v23, v31
    s_nop 1
    v_permlane32_swap_b32 v16, v20
    v_permlane32_swap_b32 v17, v21
    v_permlane32_swap_b32 v18, v22
    v_permlane32_swap_b32 v19, v23
    s_waitcnt vmcnt(0)
    v_lshlrev_b32 v24, 16, v48
    v_fma_f32 v24, v16, v52, v24
    v_and_b32 v25, 0xffff0000, v48
    v_fma_f32 v25, v17, v53, v25
    v_lshlrev_b32 v26, 16, v49
    v_fma_f32 v26, v18, v54, v26
    v_and_b32 v27, 0xffff0000, v49
    v_fma_f32 v27, v19, v55, v27
    v_lshlrev_b32 v28, 16, v50
    v_fma_f32 v28, v20, v56, v28
    v_and_b32 v29, 0xffff0000, v50
    v_fma_f32 v29, v21, v57, v29
    v_lshlrev_b32 v30, 16, v51
    v_fma_f32 v30, v22, v58, v30
    v_and_b32 v31, 0xffff0000, v51
    v_fma_f32 v31, v23, v59, v31
    v_cvt_pk_bf16_f32 v48, v24, v25
    v_cvt_pk_bf16_f32 v49, v26, v27
    v_cvt_pk_bf16_f32 v50, v28, v29
    v_cvt_pk_bf16_f32 v51, v30, v31
    buffer_store_dwordx4 v[48:51], v4, s[16:19], s36 offen sc1
    v_mov_b32 v10, 0
    v_mov_b32 v11, 0
    v_mov_b32 v6, 0x3f803f80
    v_dot2_f32_bf16 v10, v48, v6, v10
    v_dot2_f32_bf16 v11, v48, v48, v11
    v_dot2_f32_bf16 v10, v49, v6, v10
    v_dot2_f32_bf16 v11, v49, v49, v11
    v_dot2_f32_bf16 v10, v50, v6, v10
    v_dot2_f32_bf16 v11, v50, v50, v11
    v_dot2_f32_bf16 v10, v51, v6, v10
    v_dot2_f32_bf16 v11, v51, v51, v11
    s_nop 1
    v_add_f32_dpp v10, v10, v10 row_ror:8 row_mask:0xf bank_mask:0xf
    v_add_f32_dpp v11, v11, v11 row_ror:8 row_mask:0xf bank_mask:0xf
    v_mov_b32 v12, v10
    v_mov_b32 v13, v11
    s_nop 1
    v_permlane16_swap_b32 v12, v10
    v_permlane16_swap_b32 v13, v11
    s_nop 1
    v_add_f32 v10, v10, v12
    v_add_f32 v11, v11, v13
    v_mov_b32 v12, v10
    v_mov_b32 v13, v11
    s_nop 1
    v_permlane32_swap_b32 v12, v10
    v_permlane32_swap_b32 v13, v11
    s_nop 1
    v_add_f32 v10, v10, v12
    v_add_f32 v11, v11, v13
    ds_write_b64 v9, v[10:11]
    s_waitcnt lgkmcnt(0)
    s_barrier
    ds_read_b128 v[16:19], v8 offset:0
    ds_read_b128 v[20:23], v8 offset:16
    ds_read_b128 v[24:27], v8 offset:32
    ds_read_b128 v[28:31], v8 offset:48
    s_waitcnt lgkmcnt(0)
    v_add_f32 v16, v16, v24
    v_add_f32 v17, v17, v25
    v_add_f32 v18, v18, v26
    v_add_f32 v19, v19, v27
    v_add_f32 v20, v20, v28
    v_add_f32 v21, v21, v29
    v_add_f32 v22, v22, v30
    v_add_f32 v23, v23, v31
    v_add_f32 v16, v16, v20
    v_add_f32 v17, v17, v21
    v_add_f32 v18, v18, v22
    v_add_f32 v19, v19, v23
    v_add_f32 v10, v16, v18
    v_add_f32 v11, v17, v19
    v_mul_f32 v10, 0x3b000000, v10
    v_mul_f32 v11, 0x3b000000, v11
    v_fma_f32 v11, -v10, v10, v11
    v_max_f32 v11, 0, v11
    v_add_f32 v11, 0x3727c5ac, v11
    v_rsq_f32 v11, v11
    s_nop 0
    v_lshlrev_b32 v24, 16, v48
    v_sub_f32 v24, v24, v10
    v_mul_f32 v24, v24, v11
    v_add_f32 v68, 1.0, v68
    v_fma_f32 v24, v24, v68, v60
    v_and_b32 v25, 0xffff0000, v48
    v_sub_f32 v25, v25, v10
    v_mul_f32 v25, v25, v11
    v_add_f32 v69, 1.0, v69
    v_fma_f32 v25, v25, v69, v61
    v_lshlrev_b32 v26, 16, v49
    v_sub_f32 v26, v26, v10
    v_mul_f32 v26, v26, v11
    v_add_f32 v70, 1.0, v70
    v_fma_f32 v26, v26, v70, v62
    v_and_b32 v27, 0xffff0000, v49
    v_sub_f32 v27, v27, v10
    v_mul_f32 v27, v27, v11
    v_add_f32 v71, 1.0, v71
    v_fma_f32 v27, v27, v71, v63
    v_lshlrev_b32 v28, 16, v50
    v_sub_f32 v28, v28, v10
    v_mul_f32 v28, v28, v11
    v_add_f32 v72, 1.0, v72
    v_fma_f32 v28, v28, v72, v64
    v_and_b32 v29, 0xffff0000, v50
    v_sub_f32 v29, v29, v10
    v_mul_f32 v29, v29, v11
    v_add_f32 v73, 1.0, v73
    v_fma_f32 v29, v29, v73, v65
    v_lshlrev_b32 v30, 16, v51
    v_sub_f32 v30, v30, v10
    v_mul_f32 v30, v30, v11
    v_add_f32 v74, 1.0, v74
    v_fma_f32 v30, v30, v74, v66
    v_and_b32 v31, 0xffff0000, v51
    v_sub_f32 v31, v31, v10
    v_mul_f32 v31, v31, v11
    v_add_f32 v75, 1.0, v75
    v_fma_f32 v31, v31, v75, v67
    v_cvt_pk_bf16_f32 v16, v24, v25
    v_cvt_pk_bf16_f32 v17, v26, v27
    v_cvt_pk_bf16_f32 v18, v28, v29
    v_cvt_pk_bf16_f32 v19, v30, v31
    buffer_store_dwordx4 v[16:19], v4, s[28:31], s36 offen sc1
ln2_kernel_end:
    s_endpgm
.text
.globl glu_kernel
.p2align 8
.type glu_kernel,@function
glu_kernel:
    s_cmp_ge_u32 s2, 224
    s_cbranch_scc1 glu_kernel_end
    s_load_dwordx2 s[46:47], s[0:1], 56
    s_load_dwordx2 s[48:49], s[0:1], 64
    s_load_dwordx2 s[50:51], s[0:1], 112
    s_waitcnt lgkmcnt(0)
    s_and_b32 s40, s2, 1
    s_lshl_b32 s40, s40, 2
    s_bfe_u32 s35, s2, 0x20003
    s_add_u32 s40, s40, s35
    s_lshl_b32 s40, s40, 8
    s_bfe_u32 s41, s2, 0x20001
    s_mul_i32 s41, s41, 7
    s_lshr_b32 s35, s2, 5
    s_add_u32 s41, s41, s35
    s_lshl_b32 s41, s41, 6
    s_mov_b32 s42, s41
    s_add_u32 s4, s50, 0x4600000
    s_addc_u32 s5, s51, 0
    s_mov_b32 s6, 0x200000
    s_mov_b32 s7, 0x00020000
    s_mov_b32 s8, s46
    s_mov_b32 s9, s47
    s_mov_b32 s10, 0x1c0000
    s_mov_b32 s11, 0x00020000
    s_mov_b32 s12, s48
    s_mov_b32 s13, s49
    s_mov_b32 s14, 0x1c0000
    s_mov_b32 s15, 0x00020000
    s_add_u32 s16, s50, 0x4800000
    s_addc_u32 s17, s51, 0
    s_mov_b32 s18, 0x700000
    s_mov_b32 s19, 0x00020000
    v_lshrrev_b32 v1, 6, v0
    v_and_b32 v105, 63, v0
    s_nop 0
    v_readfirstlane_b32 s28, v1
    s_lshl_b32 s31, s28, 10
    s_lshr_b32 s33, s28, 3
    s_and_b32 s34, s28, 7
    s_and_b32 s35, s34, 3
    s_lshr_b32 s36, s34, 2
    v_lshrrev_b32 v106, 3, v105
    s_mul_i32 s37, s28, 8
    v_add_u32 v106, s37, v106
    v_and_b32 v107, 7, v105
    v_lshrrev_b32 v108, 1, v106
    v_and_b32 v108, 7, v108
    v_xor_b32 v107, v107, v108
    v_lshlrev_b32 v107, 4, v107
    v_add_u32 v106, s40, v106
    s_mov_b32 s37, 1024
    v_mul_lo_u32 v106, v106, s37
    v_add_u32 v100, v106, v107
    v_add_u32 v101, 0x10000, v100
    v_add_u32 v102, 0x20000, v100
    v_add_u32 v103, 0x30000, v100
    v_lshrrev_b32 v106, 3, v105
    s_mul_i32 s37, s28, 8
    v_add_u32 v106, s37, v106
    v_and_b32 v107, 7, v105
    v_lshrrev_b32 v108, 1, v106
    v_and_b32 v108, 1, v108
    v_lshlrev_b32 v108, 2, v108
    v_xor_b32 v107, v107, v108
    v_lshlrev_b32 v107, 4, v107
    s_mov_b32 s37, 3584
    v_mul_lo_u32 v106, v106, s37
    s_lshl_b32 s37, s41, 1
    v_add3_u32 v104, v106, v107, s37
    s_mov_b32 s43, 0
    s_lshr_b32 s49, s2, 3
    s_and_b32 s49, s49, 1
    s_mul_i32 s49, s49, 4
    s_mul_i32 s30, s49, 64
    s_add_u32 s30, s30, s43
    s_lshl_b32 s29, s30, 1
    s_mul_i32 s30, s30, 3584
    s_add_u32 s44, s31, 0x0
    s_add_u32 m0, s44, 0x0
    s_nop 0
    buffer_load_dwordx4 v100, s[4:7], s29 offen lds
    s_add_u32 m0, s44, 0x2000
    s_nop 0
    buffer_load_dwordx4 v101, s[4:7], s29 offen lds
    s_add_u32 m0, s44, 0x4000
    s_nop 0
    buffer_load_dwordx4 v102, s[4:7], s29 offen lds
    s_add_u32 m0, s44, 0x6000
    s_nop 0
    buffer_load_dwordx4 v103, s[4:7], s29 offen lds
    s_add_u32 m0, s44, 0x8000
    s_nop 0
    buffer_load_dwordx4 v104, s[8:11], s30 offen lds
    s_add_u32 m0, s44, 0xa000
    s_nop 0
    buffer_load_dwordx4 v104, s[12:15], s30 offen lds
    s_add_u32 s49, s49, 1
    s_cmp_ge_u32 s49, 8
    s_cselect_b32 s49, 0, s49
    s_mul_i32 s30, s49, 64
    s_add_u32 s30, s30, s43
    s_lshl_b32 s29, s30, 1
    s_mul_i32 s30, s30, 3584
    s_add_u32 s44, s31, 0xc000
    s_add_u32 m0, s44, 0x0
    s_nop 0
    buffer_load_dwordx4 v100, s[4:7], s29 offen lds
    s_add_u32 m0, s44, 0x2000
    s_nop 0
    buffer_load_dwordx4 v101, s[4:7], s29 offen lds
    s_add_u32 m0, s44, 0x4000
    s_nop 0
    buffer_load_dwordx4 v102, s[4:7], s29 offen lds
    s_add_u32 m0, s44, 0x6000
    s_nop 0
    buffer_load_dwordx4 v103, s[4:7], s29 offen lds
    s_add_u32 m0, s44, 0x8000
    s_nop 0
    buffer_load_dwordx4 v104, s[8:11], s30 offen lds
    s_add_u32 m0, s44, 0xa000
    s_nop 0
    buffer_load_dwordx4 v104, s[12:15], s30 offen lds
    s_add_u32 s49, s49, 1
    s_cmp_ge_u32 s49, 8
    s_cselect_b32 s49, 0, s49
    s_mul_i32 s30, s49, 64
    s_add_u32 s30, s30, s43
    s_lshl_b32 s29, s30, 1
    s_mul_i32 s30, s30, 3584
    s_add_u32 s44, s31, 0x18000
    s_add_u32 m0, s44, 0x0
    s_nop 0
    buffer_load_dwordx4 v100, s[4:7], s29 offen lds
    s_add_u32 m0, s44, 0x2000
    s_nop 0
    buffer_load_dwordx4 v101, s[4:7], s29 offen lds
    s_add_u32 m0, s44, 0x4000
    s_nop 0
    buffer_load_dwordx4 v102, s[4:7], s29 offen lds
    s_add_u32 m0, s44, 0x6000
    s_nop 0
    buffer_load_dwordx4 v103, s[4:7], s29 offen lds
    s_add_u32 m0, s44, 0x8000
    s_nop 0
    buffer_load_dwordx4 v104, s[8:11], s30 offen lds
    s_add_u32 m0, s44, 0xa000
    s_nop 0
    buffer_load_dwordx4 v104, s[12:15], s30 offen lds
    s_add_u32 s49, s49, 1
    s_cmp_ge_u32 s49, 8
    s_cselect_b32 s49, 0, s49
    s_mul_i32 s30, s49, 64
    s_add_u32 s30, s30, s43
    s_lshl_b32 s29, s30, 1
    s_mul_i32 s30, s30, 3584
    s_add_u32 s44, s31, 0x0
    s_mov_b32 s45, 0x0
    s_mov_b32 s48, 0xc000
    v_and_b32 v106, 31, v105
    v_lshrrev_b32 v107, 5, v105
    v_lshrrev_b32 v108, 1, v106
    v_and_b32 v108, 7, v108
    s_mul_i32 s37, s35, 64
    v_add_u32 v106, s37, v106
    v_lshlrev_b32 v106, 7, v106
    s_mul_i32 s37, s33, 8
    v_add_u32 v107, s37, v107
    v_add_u32 v109, 0, v107
    v_xor_b32 v109, v109, v108
    v_lshl_add_u32 v110, v109, 4, v106
    v_add_u32 v109, 2, v107
    v_xor_b32 v109, v109, v108
    v_lshl_add_u32 v111, v109, 4, v106
    v_add_u32 v109, 4, v107
    v_xor_b32 v109, v109, v108
    v_lshl_add_u32 v112, v109, 4, v106
    v_add_u32 v109, 6, v107
    v_xor_b32 v109, v109, v108
    v_lshl_add_u32 v113, v109, 4, v106
    v_bfe_u32 v106, v105, 2, 2
    v_lshrrev_b32 v107, 5, v105
    v_lshlrev_b32 v107, 3, v107
    v_add_u32 v107, v107, v106
    s_mul_i32 s37, s33, 64
    v_add_u32 v107, s37, v107
    v_lshlrev_b32 v107, 7, v107
    v_and_b32 v108, 3, v105
    v_lshlrev_b32 v108, 3, v108
    v_add_u32 v107, v107, v108
    v_bfe_u32 v108, v105, 4, 1
    v_lshlrev_b32 v108, 5, v108
    v_add_u32 v107, v107, v108
    v_lshrrev_b32 v106, 1, v106
    s_mul_i32 s37, s36, 1
    s_add_u32 s38, s37, 0
    v_xor_b32 v108, s38, v106
    v_lshl_add_u32 v108, v108, 6, v107
    v_add_u32 v114, 0x8000, v108
    s_add_u32 s38, s37, 0
    v_xor_b32 v108, s38, v106
    v_lshl_add_u32 v108, v108, 6, v107
    v_add_u32 v115, 0xa000, v108
    s_waitcnt vmcnt(12)
    s_barrier
    ds_read_b128 v[68:71], v110 offset:0
    ds_read_b128 v[72:75], v110 offset:4096
    ds_read_b64_tr_b16 v[76:77], v114 offset:0
    ds_read_b64_tr_b16 v[78:79], v114 offset:512
    ds_read_b64_tr_b16 v[80:81], v115 offset:0
    ds_read_b64_tr_b16 v[82:83], v115 offset:512
    ds_read_b128 v[84:87], v111 offset:0
    ds_read_b128 v[88:91], v111 offset:4096
    ds_read_b64_tr_b16 v[92:93], v114 offset:2048
    ds_read_b64_tr_b16 v[94:95], v114 offset:2560
    ds_read_b64_tr_b16 v[96:97], v115 offset:2048
    ds_read_b64_tr_b16 v[98:99], v115 offset:2560
    s_waitcnt lgkmcnt(6)
    v_mfma_f32_32x32x16_bf16 v[4:19], v[76:79], v[68:71], 0
    v_mfma_f32_32x32x16_bf16 v[20:35], v[80:83], v[68:71], 0
    v_mfma_f32_32x32x16_bf16 v[36:51], v[76:79], v[72:75], 0
    v_mfma_f32_32x32x16_bf16 v[52:67], v[80:83], v[72:75], 0
    ds_read_b128 v[68:71], v112 offset:0
    ds_read_b128 v[72:75], v112 offset:4096
    ds_read_b64_tr_b16 v[76:77], v114 offset:4096
    ds_read_b64_tr_b16 v[78:79], v114 offset:4608
    ds_read_b64_tr_b16 v[80:81], v115 offset:4096
    ds_read_b64_tr_b16 v[82:83], v115 offset:4608
    s_waitcnt lgkmcnt(6)
    v_mfma_f32_32x32x16_bf16 v[4:19], v[92:95], v[84:87], v[4:19]
    v_mfma_f32_32x32x16_bf16 v[20:35], v[96:99], v[84:87], v[20:35]
    v_mfma_f32_32x32x16_bf16 v[36:51], v[92:95], v[88:91], v[36:51]
    v_mfma_f32_32x32x16_bf16 v[52:67], v[96:99], v[88:91], v[52:67]
    ds_read_b128 v[84:87], v113 offset:0
    ds_read_b128 v[88:91], v113 offset:4096
    ds_read_b64_tr_b16 v[92:93], v114 offset:6144
    ds_read_b64_tr_b16 v[94:95], v114 offset:6656
    ds_read_b64_tr_b16 v[96:97], v115 offset:6144
    ds_read_b64_tr_b16 v[98:99], v115 offset:6656
    s_waitcnt lgkmcnt(6)
    v_mfma_f32_32x32x16_bf16 v[4:19], v[76:79], v[68:71], v[4:19]
    v_mfma_f32_32x32x16_bf16 v[20:35], v[80:83], v[68:71], v[20:35]
    v_mfma_f32_32x32x16_bf16 v[36:51], v[76:79], v[72:75], v[36:51]
    v_mfma_f32_32x32x16_bf16 v[52:67], v[80:83], v[72:75], v[52:67]
    s_waitcnt lgkmcnt(0)
    v_mfma_f32_32x32x16_bf16 v[4:19], v[92:95], v[84:87], v[4:19]
    v_mfma_f32_32x32x16_bf16 v[20:35], v[96:99], v[84:87], v[20:35]
    s_add_u32 s45, s45, 0xc000
    s_cmp_ge_u32 s45, 0x24000
    s_cselect_b32 s46, 0xfffe8000, s48
    s_cselect_b32 s45, 0, s45
    v_add_u32 v110, s46, v110
    v_add_u32 v111, s46, v111
    v_add_u32 v112, s46, v112
    v_add_u32 v113, s46, v113
    v_add_u32 v114, s46, v114
    v_add_u32 v115, s46, v115
    s_waitcnt vmcnt(6)
    s_barrier
    ds_read_b128 v[68:71], v110 offset:0
    ds_read_b128 v[72:75], v110 offset:4096
    ds_read_b64_tr_b16 v[76:77], v114 offset:0
    ds_read_b64_tr_b16 v[78:79], v114 offset:512
    ds_read_b64_tr_b16 v[80:81], v115 offset:0
    ds_read_b64_tr_b16 v[82:83], v115 offset:512
    v_mfma_f32_32x32x16_bf16 v[36:51], v[92:95], v[88:91], v[36:51]
    v_mfma_f32_32x32x16_bf16 v[52:67], v[96:99], v[88:91], v[52:67]
    s_mov_b32 s47, 5
glu_kernel_loop:
    ds_read_b128 v[84:87], v111 offset:0
    ds_read_b128 v[88:91], v111 offset:4096
    ds_read_b64_tr_b16 v[92:93], v114 offset:2048
    ds_read_b64_tr_b16 v[94:95], v114 offset:2560
    ds_read_b64_tr_b16 v[96:97], v115 offset:2048
    ds_read_b64_tr_b16 v[98:99], v115 offset:2560
    s_waitcnt lgkmcnt(6)
    v_mfma_f32_32x32x16_bf16 v[4:19], v[76:79], v[68:71], v[4:19]
    s_add_u32 m0, s44, 0x0
    s_nop 0
    buffer_load_dwordx4 v100, s[4:7], s29 offen lds
    v_mfma_f32_32x32x16_bf16 v[20:35], v[80:83], v[68:71], v[20:35]
    s_add_u32 m0, s44, 0x2000
    s_nop 0
    buffer_load_dwordx4 v101, s[4:7], s29 offen lds
    v_mfma_f32_32x32x16_bf16 v[36:51], v[76:79], v[72:75], v[36:51]
    s_add_u32 m0, s44, 0x4000
    s_nop 0
    buffer_load_dwordx4 v102, s[4:7], s29 offen lds
    v_mfma_f32_32x32x16_bf16 v[52:67], v[80:83], v[72:75], v[52:67]
    s_add_u32 m0, s44, 0x6000
    s_nop 0
    buffer_load_dwordx4 v103, s[4:7], s29 offen lds
    ds_read_b128 v[68:71], v112 offset:0
    ds_read_b128 v[72:75], v112 offset:4096
    ds_read_b64_tr_b16 v[76:77], v114 offset:4096
    ds_read_b64_tr_b16 v[78:79], v114 offset:4608
    ds_read_b64_tr_b16 v[80:81], v115 offset:4096
    ds_read_b64_tr_b16 v[82:83], v115 offset:4608
    s_waitcnt lgkmcnt(6)
    v_mfma_f32_32x32x16_bf16 v[4:19], v[92:95], v[84:87], v[4:19]
    s_add_u32 m0, s44, 0x8000
    s_nop 0
    buffer_load_dwordx4 v104, s[8:11], s30 offen lds
    v_mfma_f32_32x32x16_bf16 v[20:35], v[96:99], v[84:87], v[20:35]
    s_add_u32 m0, s44, 0xa000
    s_nop 0
    buffer_load_dwordx4 v104, s[12:15], s30 offen lds
    s_add_u32 s49, s49, 1
    s_cmp_ge_u32 s49, 8
    s_cselect_b32 s49, 0, s49
    s_mul_i32 s30, s49, 64
    s_add_u32 s30, s30, s43
    s_lshl_b32 s29, s30, 1
    s_mul_i32 s30, s30, 3584
    s_add_u32 s44, s44, 0xc000
    s_sub_u32 s46, s44, s31
    s_cmp_ge_u32 s46, 0x24000
    s_cselect_b32 s44, s31, s44
    v_mfma_f32_32x32x16_bf16 v[36:51], v[92:95], v[88:91], v[36:51]
    v_mfma_f32_32x32x16_bf16 v[52:67], v[96:99], v[88:91], v[52:67]
    ds_read_b128 v[84:87], v113 offset:0
    ds_read_b128 v[88:91], v113 offset:4096
    ds_read_b64_tr_b16 v[92:93], v114 offset:6144
    ds_read_b64_tr_b16 v[94:95], v114 offset:6656
    ds_read_b64_tr_b16 v[96:97], v115 offset:6144
    ds_read_b64_tr_b16 v[98:99], v115 offset:6656
    s_waitcnt lgkmcnt(6)
    v_mfma_f32_32x32x16_bf16 v[4:19], v[76:79], v[68:71], v[4:19]
    v_mfma_f32_32x32x16_bf16 v[20:35], v[80:83], v[68:71], v[20:35]
    v_mfma_f32_32x32x16_bf16 v[36:51], v[76:79], v[72:75], v[36:51]
    v_mfma_f32_32x32x16_bf16 v[52:67], v[80:83], v[72:75], v[52:67]
    s_waitcnt lgkmcnt(0)
    v_mfma_f32_32x32x16_bf16 v[4:19], v[92:95], v[84:87], v[4:19]
    v_mfma_f32_32x32x16_bf16 v[20:35], v[96:99], v[84:87], v[20:35]
    s_add_u32 s45, s45, 0xc000
    s_cmp_ge_u32 s45, 0x24000
    s_cselect_b32 s46, 0xfffe8000, s48
    s_cselect_b32 s45, 0, s45
    v_add_u32 v110, s46, v110
    v_add_u32 v111, s46, v111
    v_add_u32 v112, s46, v112
    v_add_u32 v113, s46, v113
    v_add_u32 v114, s46, v114
    v_add_u32 v115, s46, v115
    s_waitcnt vmcnt(6)
    s_barrier
    ds_read_b128 v[68:71], v110 offset:0
    ds_read_b128 v[72:75], v110 offset:4096
    ds_read_b64_tr_b16 v[76:77], v114 offset:0
    ds_read_b64_tr_b16 v[78:79], v114 offset:512
    ds_read_b64_tr_b16 v[80:81], v115 offset:0
    ds_read_b64_tr_b16 v[82:83], v115 offset:512
    v_mfma_f32_32x32x16_bf16 v[36:51], v[92:95], v[88:91], v[36:51]
    v_mfma_f32_32x32x16_bf16 v[52:67], v[96:99], v[88:91], v[52:67]
    s_sub_u32 s47, s47, 1
    s_cmp_lg_u32 s47, 0
    s_cbranch_scc1 glu_kernel_loop
    ds_read_b128 v[84:87], v111 offset:0
    ds_read_b128 v[88:91], v111 offset:4096
    ds_read_b64_tr_b16 v[92:93], v114 offset:2048
    ds_read_b64_tr_b16 v[94:95], v114 offset:2560
    ds_read_b64_tr_b16 v[96:97], v115 offset:2048
    ds_read_b64_tr_b16 v[98:99], v115 offset:2560
    s_waitcnt lgkmcnt(6)
    v_mfma_f32_32x32x16_bf16 v[4:19], v[76:79], v[68:71], v[4:19]
    v_mfma_f32_32x32x16_bf16 v[20:35], v[80:83], v[68:71], v[20:35]
    v_mfma_f32_32x32x16_bf16 v[36:51], v[76:79], v[72:75], v[36:51]
    v_mfma_f32_32x32x16_bf16 v[52:67], v[80:83], v[72:75], v[52:67]
    ds_read_b128 v[68:71], v112 offset:0
    ds_read_b128 v[72:75], v112 offset:4096
    ds_read_b64_tr_b16 v[76:77], v114 offset:4096
    ds_read_b64_tr_b16 v[78:79], v114 offset:4608
    ds_read_b64_tr_b16 v[80:81], v115 offset:4096
    ds_read_b64_tr_b16 v[82:83], v115 offset:4608
    s_waitcnt lgkmcnt(6)
    v_mfma_f32_32x32x16_bf16 v[4:19], v[92:95], v[84:87], v[4:19]
    v_mfma_f32_32x32x16_bf16 v[20:35], v[96:99], v[84:87], v[20:35]
    v_mfma_f32_32x32x16_bf16 v[36:51], v[92:95], v[88:91], v[36:51]
    v_mfma_f32_32x32x16_bf16 v[52:67], v[96:99], v[88:91], v[52:67]
    ds_read_b128 v[84:87], v113 offset:0
    ds_read_b128 v[88:91], v113 offset:4096
    ds_read_b64_tr_b16 v[92:93], v114 offset:6144
    ds_read_b64_tr_b16 v[94:95], v114 offset:6656
    ds_read_b64_tr_b16 v[96:97], v115 offset:6144
    ds_read_b64_tr_b16 v[98:99], v115 offset:6656
    s_waitcnt lgkmcnt(6)
    v_mfma_f32_32x32x16_bf16 v[4:19], v[76:79], v[68:71], v[4:19]
    v_mfma_f32_32x32x16_bf16 v[20:35], v[80:83], v[68:71], v[20:35]
    v_mfma_f32_32x32x16_bf16 v[36:51], v[76:79], v[72:75], v[36:51]
    v_mfma_f32_32x32x16_bf16 v[52:67], v[80:83], v[72:75], v[52:67]
    s_waitcnt lgkmcnt(0)
    v_mfma_f32_32x32x16_bf16 v[4:19], v[92:95], v[84:87], v[4:19]
    v_mfma_f32_32x32x16_bf16 v[20:35], v[96:99], v[84:87], v[20:35]
    s_add_u32 s45, s45, 0xc000
    s_cmp_ge_u32 s45, 0x24000
    s_cselect_b32 s46, 0xfffe8000, s48
    s_cselect_b32 s45, 0, s45
    v_add_u32 v110, s46, v110
    v_add_u32 v111, s46, v111
    v_add_u32 v112, s46, v112
    v_add_u32 v113, s46, v113
    v_add_u32 v114, s46, v114
    v_add_u32 v115, s46, v115
    s_waitcnt vmcnt(0)
    s_barrier
    ds_read_b128 v[68:71], v110 offset:0
    ds_read_b128 v[72:75], v110 offset:4096
    ds_read_b64_tr_b16 v[76:77], v114 offset:0
    ds_read_b64_tr_b16 v[78:79], v114 offset:512
    ds_read_b64_tr_b16 v[80:81], v115 offset:0
    ds_read_b64_tr_b16 v[82:83], v115 offset:512
    v_mfma_f32_32x32x16_bf16 v[36:51], v[92:95], v[88:91], v[36:51]
    v_mfma_f32_32x32x16_bf16 v[52:67], v[96:99], v[88:91], v[52:67]
    ds_read_b128 v[84:87], v111 offset:0
    ds_read_b128 v[88:91], v111 offset:4096
    ds_read_b64_tr_b16 v[92:93], v114 offset:2048
    ds_read_b64_tr_b16 v[94:95], v114 offset:2560
    ds_read_b64_tr_b16 v[96:97], v115 offset:2048
    ds_read_b64_tr_b16 v[98:99], v115 offset:2560
    s_waitcnt lgkmcnt(6)
    v_mfma_f32_32x32x16_bf16 v[4:19], v[76:79], v[68:71], v[4:19]
    v_mfma_f32_32x32x16_bf16 v[20:35], v[80:83], v[68:71], v[20:35]
    v_mfma_f32_32x32x16_bf16 v[36:51], v[76:79], v[72:75], v[36:51]
    v_mfma_f32_32x32x16_bf16 v[52:67], v[80:83], v[72:75], v[52:67]
    ds_read_b128 v[68:71], v112 offset:0
    ds_read_b128 v[72:75], v112 offset:4096
    ds_read_b64_tr_b16 v[76:77], v114 offset:4096
    ds_read_b64_tr_b16 v[78:79], v114 offset:4608
    ds_read_b64_tr_b16 v[80:81], v115 offset:4096
    ds_read_b64_tr_b16 v[82:83], v115 offset:4608
    s_waitcnt lgkmcnt(6)
    v_mfma_f32_32x32x16_bf16 v[4:19], v[92:95], v[84:87], v[4:19]
    v_mfma_f32_32x32x16_bf16 v[20:35], v[96:99], v[84:87], v[20:35]
    v_mfma_f32_32x32x16_bf16 v[36:51], v[92:95], v[88:91], v[36:51]
    v_mfma_f32_32x32x16_bf16 v[52:67], v[96:99], v[88:91], v[52:67]
    ds_read_b128 v[84:87], v113 offset:0
    ds_read_b128 v[88:91], v113 offset:4096
    ds_read_b64_tr_b16 v[92:93], v114 offset:6144
    ds_read_b64_tr_b16 v[94:95], v114 offset:6656
    ds_read_b64_tr_b16 v[96:97], v115 offset:6144
    ds_read_b64_tr_b16 v[98:99], v115 offset:6656
    s_waitcnt lgkmcnt(6)
    v_mfma_f32_32x32x16_bf16 v[4:19], v[76:79], v[68:71], v[4:19]
    v_mfma_f32_32x32x16_bf16 v[20:35], v[80:83], v[68:71], v[20:35]
    v_mfma_f32_32x32x16_bf16 v[36:51], v[76:79], v[72:75], v[36:51]
    v_mfma_f32_32x32x16_bf16 v[52:67], v[80:83], v[72:75], v[52:67]
    s_waitcnt lgkmcnt(0)
    v_mfma_f32_32x32x16_bf16 v[4:19], v[92:95], v[84:87], v[4:19]
    v_mfma_f32_32x32x16_bf16 v[20:35], v[96:99], v[84:87], v[20:35]
    v_mfma_f32_32x32x16_bf16 v[36:51], v[92:95], v[88:91], v[36:51]
    v_mfma_f32_32x32x16_bf16 v[52:67], v[96:99], v[88:91], v[52:67]
    s_nop 15
    s_nop 3
    v_and_b32 v106, 31, v105
    v_lshrrev_b32 v107, 5, v105
    s_mul_i32 s37, s35, 64
    s_add_u32 s37, s37, s40
    s_mul_i32 s38, s36, 32
    s_add_u32 s38, s38, s42
    s_mov_b32 s39, 3584
    s_lshr_b32 s37, s37, 5
    s_mul_i32 s39, s37, 114688
    s_lshl_b32 s38, s38, 6
    s_add_u32 s39, s39, s38
    v_lshl_add_u32 v106, v105, 4, s39
    v_max_f32 v4, 0, v4
    v_max_f32 v5, 0, v5
    v_max_f32 v6, 0, v6
    v_max_f32 v7, 0, v7
    v_max_f32 v8, 0, v8
    v_max_f32 v9, 0, v9
    v_max_f32 v10, 0, v10
    v_max_f32 v11, 0, v11
    v_max_f32 v12, 0, v12
    v_max_f32 v13, 0, v13
    v_max_f32 v14, 0, v14
    v_max_f32 v15, 0, v15
    v_max_f32 v16, 0, v16
    v_max_f32 v17, 0, v17
    v_max_f32 v18, 0, v18
    v_max_f32 v19, 0, v19
    v_mul_f32 v4, v4, v20
    v_mul_f32 v5, v5, v21
    v_mul_f32 v6, v6, v22
    v_mul_f32 v7, v7, v23
    v_mul_f32 v8, v8, v24
    v_mul_f32 v9, v9, v25
    v_mul_f32 v10, v10, v26
    v_mul_f32 v11, v11, v27
    v_mul_f32 v12, v12, v28
    v_mul_f32 v13, v13, v29
    v_mul_f32 v14, v14, v30
    v_mul_f32 v15, v15, v31
    v_mul_f32 v16, v16, v32
    v_mul_f32 v17, v17, v33
    v_mul_f32 v18, v18, v34
    v_mul_f32 v19, v19, v35
    v_cvt_pk_bf16_f32 v68, v4, v5
    v_cvt_pk_bf16_f32 v69, v6, v7
    v_cvt_pk_bf16_f32 v70, v8, v9
    v_cvt_pk_bf16_f32 v71, v10, v11
    s_mov_b32 s39, 0x0
    buffer_store_dwordx4 v[68:71], v106, s[16:19], s39 offen offset:0 sc1
    v_cvt_pk_bf16_f32 v72, v12, v13
    v_cvt_pk_bf16_f32 v73, v14, v15
    v_cvt_pk_bf16_f32 v74, v16, v17
    v_cvt_pk_bf16_f32 v75, v18, v19
    s_mov_b32 s39, 0x0
    buffer_store_dwordx4 v[72:75], v106, s[16:19], s39 offen offset:1024 sc1
    v_max_f32 v36, 0, v36
    v_max_f32 v37, 0, v37
    v_max_f32 v38, 0, v38
    v_max_f32 v39, 0, v39
    v_max_f32 v40, 0, v40
    v_max_f32 v41, 0, v41
    v_max_f32 v42, 0, v42
    v_max_f32 v43, 0, v43
    v_max_f32 v44, 0, v44
    v_max_f32 v45, 0, v45
    v_max_f32 v46, 0, v46
    v_max_f32 v47, 0, v47
    v_max_f32 v48, 0, v48
    v_max_f32 v49, 0, v49
    v_max_f32 v50, 0, v50
    v_max_f32 v51, 0, v51
    v_mul_f32 v36, v36, v52
    v_mul_f32 v37, v37, v53
    v_mul_f32 v38, v38, v54
    v_mul_f32 v39, v39, v55
    v_mul_f32 v40, v40, v56
    v_mul_f32 v41, v41, v57
    v_mul_f32 v42, v42, v58
    v_mul_f32 v43, v43, v59
    v_mul_f32 v44, v44, v60
    v_mul_f32 v45, v45, v61
    v_mul_f32 v46, v46, v62
    v_mul_f32 v47, v47, v63
    v_mul_f32 v48, v48, v64
    v_mul_f32 v49, v49, v65
    v_mul_f32 v50, v50, v66
    v_mul_f32 v51, v51, v67
    v_cvt_pk_bf16_f32 v76, v36, v37
    v_cvt_pk_bf16_f32 v77, v38, v39
    v_cvt_pk_bf16_f32 v78, v40, v41
    v_cvt_pk_bf16_f32 v79, v42, v43
    s_mov_b32 s39, 0x1c000
    buffer_store_dwordx4 v[76:79], v106, s[16:19], s39 offen offset:0 sc1
    v_cvt_pk_bf16_f32 v80, v44, v45
    v_cvt_pk_bf16_f32 v81, v46, v47
    v_cvt_pk_bf16_f32 v82, v48, v49
    v_cvt_pk_bf16_f32 v83, v50, v51
    s_mov_b32 s39, 0x1c000
    buffer_store_dwordx4 v[80:83], v106, s[16:19], s39 offen offset:1024 sc1
    s_endpgm
glu_kernel_end:
    s_endpgm
.text
.globl down_kernel
.p2align 8
.type down_kernel,@function
down_kernel:
    s_cmp_ge_u32 s2, 256
    s_cbranch_scc1 down_kernel_end
    s_load_dwordx2 s[46:47], s[0:1], 72
    s_load_dwordx2 s[50:51], s[0:1], 112
    s_load_dwordx2 s[44:45], s[0:1], 0
    s_load_dwordx2 s[48:49], s[0:1], 96
    s_waitcnt lgkmcnt(0)
    s_and_b32 s40, s2, 7
    s_lshl_b32 s40, s40, 2
    s_lshr_b32 s35, s2, 3
    s_and_b32 s35, s35, 3
    s_add_u32 s40, s40, s35
    s_lshl_b32 s40, s40, 6
    s_lshr_b32 s41, s2, 5
    s_lshl_b32 s41, s41, 6
    s_mov_b32 s42, s41
    s_add_u32 s4, s50, 0x4800000
    s_addc_u32 s5, s51, 0
    s_mov_b32 s6, 0x700000
    s_mov_b32 s7, 0x00020000
    s_mov_b32 s8, s46
    s_mov_b32 s9, s47
    s_mov_b32 s10, 0x1c0000
    s_mov_b32 s11, 0x00020000
    s_mov_b32 s16, s48
    s_mov_b32 s17, s49
    s_mov_b32 s18, 0x200000
    s_mov_b32 s19, 0x00020000
    s_add_u32 s20, s50, 0x4400000
    s_addc_u32 s21, s51, 0
    s_mov_b32 s22, 0x200000
    s_mov_b32 s23, 0x00020000
    s_add_u32 s24, s50, 0x2800
    s_addc_u32 s25, s51, 0
    s_mov_b32 s26, 0x800
    s_mov_b32 s27, 0x00020000
    v_lshrrev_b32 v1, 6, v0
    v_and_b32 v40, 63, v0
    s_nop 0
    v_readfirstlane_b32 s28, v1
    s_lshl_b32 s31, s28, 10
    s_lshr_b32 s33, s28, 2
    s_and_b32 s34, s28, 3
    s_and_b32 s35, s34, 1
    s_lshr_b32 s36, s34, 1
    s_lshr_b32 s37, s28, 3
    s_lshr_b32 s38, s40, 5
    s_add_u32 s37, s37, s38
    s_mul_i32 s37, s37, 114688
    s_and_b32 s38, s28, 7
    s_lshl_b32 s38, s38, 10
    s_add_u32 s37, s37, s38
    v_lshl_add_u32 v36, v40, 4, s37
    v_add_u32 v37, 0x1c000, v36
    v_lshrrev_b32 v41, 3, v40
    s_mul_i32 s37, s28, 8
    v_add_u32 v41, s37, v41
    v_and_b32 v42, 7, v40
    v_lshrrev_b32 v43, 1, v41
    v_and_b32 v43, 1, v43
    v_lshlrev_b32 v43, 2, v43
    v_xor_b32 v42, v42, v43
    v_lshlrev_b32 v42, 4, v42
    s_mov_b32 s37, 1024
    v_mul_lo_u32 v41, v41, s37
    s_lshl_b32 s37, s41, 1
    v_add3_u32 v38, v41, v42, s37
    v_add_u32 v39, 0x10000, v38
    s_mov_b32 s43, 0
    s_lshr_b32 s49, s2, 3
    s_and_b32 s49, s49, 1
    s_mul_i32 s49, s49, 7
    s_mul_i32 s30, s49, 128
    s_add_u32 s30, s30, s43
    s_lshl_b32 s29, s30, 6
    s_mul_i32 s30, s30, 1024
    s_add_u32 s44, s31, 0x0
    s_add_u32 m0, s44, 0x0
    s_nop 0
    buffer_load_dwordx4 v36, s[4:7], s29 offen lds
    s_add_u32 m0, s44, 0x2000
    s_nop 0
    buffer_load_dwordx4 v37, s[4:7], s29 offen lds
    s_add_u32 m0, s44, 0x4000
    s_nop 0
    buffer_load_dwordx4 v38, s[8:11], s30 offen lds
    s_add_u32 m0, s44, 0x6000
    s_nop 0
    buffer_load_dwordx4 v39, s[8:11], s30 offen lds
    s_add_u32 s49, s49, 1
    s_cmp_ge_u32 s49, 14
    s_cselect_b32 s49, 0, s49
    s_mul_i32 s30, s49, 128
    s_add_u32 s30, s30, s43
    s_lshl_b32 s29, s30, 6
    s_mul_i32 s30, s30, 1024
    s_add_u32 s44, s31, 0x8000
    s_add_u32 m0, s44, 0x0
    s_nop 0
    buffer_load_dwordx4 v36, s[4:7], s29 offen lds
    s_add_u32 m0, s44, 0x2000
    s_nop 0
    buffer_load_dwordx4 v37, s[4:7], s29 offen lds
    s_add_u32 m0, s44, 0x4000
    s_nop 0
    buffer_load_dwordx4 v38, s[8:11], s30 offen lds
    s_add_u32 m0, s44, 0x6000
    s_nop 0
    buffer_load_dwordx4 v39, s[8:11], s30 offen lds
    s_add_u32 s49, s49, 1
    s_cmp_ge_u32 s49, 14
    s_cselect_b32 s49, 0, s49
    s_mul_i32 s30, s49, 128
    s_add_u32 s30, s30, s43
    s_lshl_b32 s29, s30, 6
    s_mul_i32 s30, s30, 1024
    s_add_u32 s44, s31, 0x10000
    s_add_u32 m0, s44, 0x0
    s_nop 0
    buffer_load_dwordx4 v36, s[4:7], s29 offen lds
    s_add_u32 m0, s44, 0x2000
    s_nop 0
    buffer_load_dwordx4 v37, s[4:7], s29 offen lds
    s_add_u32 m0, s44, 0x4000
    s_nop 0
    buffer_load_dwordx4 v38, s[8:11], s30 offen lds
    s_add_u32 m0, s44, 0x6000
    s_nop 0
    buffer_load_dwordx4 v39, s[8:11], s30 offen lds
    s_add_u32 s49, s49, 1
    s_cmp_ge_u32 s49, 14
    s_cselect_b32 s49, 0, s49
    s_mul_i32 s30, s49, 128
    s_add_u32 s30, s30, s43
    s_lshl_b32 s29, s30, 6
    s_mul_i32 s30, s30, 1024
    s_add_u32 s44, s31, 0x18000
    s_add_u32 m0, s44, 0x0
    s_nop 0
    buffer_load_dwordx4 v36, s[4:7], s29 offen lds
    s_add_u32 m0, s44, 0x2000
    s_nop 0
    buffer_load_dwordx4 v37, s[4:7], s29 offen lds
    s_add_u32 m0, s44, 0x4000
    s_nop 0
    buffer_load_dwordx4 v38, s[8:11], s30 offen lds
    s_add_u32 m0, s44, 0x6000
    s_nop 0
    buffer_load_dwordx4 v39, s[8:11], s30 offen lds
    s_add_u32 s49, s49, 1
    s_cmp_ge_u32 s49, 14
    s_cselect_b32 s49, 0, s49
    s_mul_i32 s30, s49, 128
    s_add_u32 s30, s30, s43
    s_lshl_b32 s29, s30, 6
    s_mul_i32 s30, s30, 1024
    s_add_u32 s44, s31, 0x0
    s_mov_b32 s45, 0x0
    s_mov_b32 s48, 0x8000
    v_lshrrev_b32 v41, 3, v0
    v_and_b32 v42, 7, v0
    v_mul_u32_u24 v61, 272, v41
    v_lshl_add_u32 v61, v42, 5, v61
    v_add_u32 v41, s40, v41
    v_lshlrev_b32 v41, 10, v41
    v_lshl_add_u32 v41, v42, 4, v41
    s_lshl_b32 s37, s42, 1
    v_add_u32 v60, s37, v41
    v_lshlrev_b32 v42, 5, v42
    s_lshl_b32 s37, s42, 2
    buffer_load_dwordx4 v[48:51], v60, s[20:23], 0 offen
    buffer_load_dwordx4 v[52:55], v42, s[24:27], s37 offen offset:0
    buffer_load_dwordx4 v[56:59], v42, s[24:27], s37 offen offset:16
    s_mul_i32 s37, s35, 8192
    s_mul_i32 s38, s33, 4096
    s_add_u32 s37, s37, s38
    v_lshl_add_u32 v62, v40, 4, s37
    v_bfe_u32 v41, v40, 2, 2
    v_lshrrev_b32 v42, 5, v40
    v_lshlrev_b32 v42, 2, v42
    v_add_u32 v42, v42, v41
    s_mul_i32 s37, s33, 64
    v_add_u32 v42, s37, v42
    v_lshlrev_b32 v42, 7, v42
    v_and_b32 v43, 3, v40
    v_lshlrev_b32 v43, 3, v43
    v_add_u32 v42, v42, v43
    v_bfe_u32 v43, v40, 4, 1
    v_lshlrev_b32 v43, 5, v43
    v_add_u32 v42, v42, v43
    v_lshrrev_b32 v41, 1, v41
    s_mul_i32 s37, s36, 1
    s_add_u32 s38, s37, 0
    v_xor_b32 v43, s38, v41
    v_lshl_add_u32 v43, v43, 6, v42
    v_add_u32 v63, 0x4000, v43
    s_waitcnt vmcnt(15)
    s_barrier
    ds_read_b128 v[20:23], v62 offset:0
    ds_read_b64_tr_b16 v[24:25], v63 offset:0
    ds_read_b64_tr_b16 v[26:27], v63 offset:1024
    ds_read_b128 v[28:31], v62 offset:1024
    ds_read_b64_tr_b16 v[32:33], v63 offset:2048
    ds_read_b64_tr_b16 v[34:35], v63 offset:3072
    s_waitcnt lgkmcnt(3)
    v_mfma_f32_32x32x16_bf16 v[4:19], v[24:27], v[20:23], 0
    ds_read_b128 v[20:23], v62 offset:2048
    ds_read_b64_tr_b16 v[24:25], v63 offset:4096
    ds_read_b64_tr_b16 v[26:27], v63 offset:5120
    s_waitcnt lgkmcnt(3)
    v_mfma_f32_32x32x16_bf16 v[4:19], v[32:35], v[28:31], v[4:19]
    ds_read_b128 v[28:31], v62 offset:3072
    ds_read_b64_tr_b16 v[32:33], v63 offset:6144
    ds_read_b64_tr_b16 v[34:35], v63 offset:7168
    s_waitcnt lgkmcnt(3)
    v_mfma_f32_32x32x16_bf16 v[4:19], v[24:27], v[20:23], v[4:19]
    s_waitcnt lgkmcnt(0)
    s_add_u32 s45, s45, 0x8000
    s_cmp_ge_u32 s45, 0x20000
    s_cselect_b32 s46, 0xfffe8000, s48
    s_cselect_b32 s45, 0, s45
    v_add_u32 v62, s46, v62
    v_add_u32 v63, s46, v63
    s_waitcnt vmcnt(11)
    s_barrier
    ds_read_b128 v[20:23], v62 offset:0
    ds_read_b64_tr_b16 v[24:25], v63 offset:0
    ds_read_b64_tr_b16 v[26:27], v63 offset:1024
    v_mfma_f32_32x32x16_bf16 v[4:19], v[32:35], v[28:31], v[4:19]
    s_mov_b32 s47, 10
down_kernel_loop:
    ds_read_b128 v[28:31], v62 offset:1024
    ds_read_b64_tr_b16 v[32:33], v63 offset:2048
    ds_read_b64_tr_b16 v[34:35], v63 offset:3072
    s_waitcnt lgkmcnt(3)
    v_mfma_f32_32x32x16_bf16 v[4:19], v[24:27], v[20:23], v[4:19]
    s_add_u32 m0, s44, 0x0
    s_nop 0
    buffer_load_dwordx4 v36, s[4:7], s29 offen lds
    ds_read_b128 v[20:23], v62 offset:2048
    ds_read_b64_tr_b16 v[24:25], v63 offset:4096
    ds_read_b64_tr_b16 v[26:27], v63 offset:5120
    s_waitcnt lgkmcnt(3)
    v_mfma_f32_32x32x16_bf16 v[4:19], v[32:35], v[28:31], v[4:19]
    s_add_u32 m0, s44, 0x2000
    s_nop 0
    buffer_load_dwordx4 v37, s[4:7], s29 offen lds
    ds_read_b128 v[28:31], v62 offset:3072
    ds_read_b64_tr_b16 v[32:33], v63 offset:6144
    ds_read_b64_tr_b16 v[34:35], v63 offset:7168
    s_waitcnt lgkmcnt(3)
    v_mfma_f32_32x32x16_bf16 v[4:19], v[24:27], v[20:23], v[4:19]
    s_add_u32 m0, s44, 0x4000
    s_nop 0
    buffer_load_dwordx4 v38, s[8:11], s30 offen lds
    s_waitcnt lgkmcnt(0)
    s_add_u32 m0, s44, 0x6000
    s_nop 0
    buffer_load_dwordx4 v39, s[8:11], s30 offen lds
    s_add_u32 s49, s49, 1
    s_cmp_ge_u32 s49, 14
    s_cselect_b32 s49, 0, s49
    s_mul_i32 s30, s49, 128
    s_add_u32 s30, s30, s43
    s_lshl_b32 s29, s30, 6
    s_mul_i32 s30, s30, 1024
    s_add_u32 s44, s44, 0x8000
    s_sub_u32 s46, s44, s31
    s_cmp_ge_u32 s46, 0x20000
    s_cselect_b32 s44, s31, s44
    s_add_u32 s45, s45, 0x8000
    s_cmp_ge_u32 s45, 0x20000
    s_cselect_b32 s46, 0xfffe8000, s48
    s_cselect_b32 s45, 0, s45
    v_add_u32 v62, s46, v62
    v_add_u32 v63, s46, v63
    s_waitcnt vmcnt(8)
    s_barrier
    ds_read_b128 v[20:23], v62 offset:0
    ds_read_b64_tr_b16 v[24:25], v63 offset:0
    ds_read_b64_tr_b16 v[26:27], v63 offset:1024
    v_mfma_f32_32x32x16_bf16 v[4:19], v[32:35], v[28:31], v[4:19]
    s_sub_u32 s47, s47, 1
    s_cmp_lg_u32 s47, 0
    s_cbranch_scc1 down_kernel_loop
    ds_read_b128 v[28:31], v62 offset:1024
    ds_read_b64_tr_b16 v[32:33], v63 offset:2048
    ds_read_b64_tr_b16 v[34:35], v63 offset:3072
    s_waitcnt lgkmcnt(3)
    v_mfma_f32_32x32x16_bf16 v[4:19], v[24:27], v[20:23], v[4:19]
    ds_read_b128 v[20:23], v62 offset:2048
    ds_read_b64_tr_b16 v[24:25], v63 offset:4096
    ds_read_b64_tr_b16 v[26:27], v63 offset:5120
    s_waitcnt lgkmcnt(3)
    v_mfma_f32_32x32x16_bf16 v[4:19], v[32:35], v[28:31], v[4:19]
    ds_read_b128 v[28:31], v62 offset:3072
    ds_read_b64_tr_b16 v[32:33], v63 offset:6144
    ds_read_b64_tr_b16 v[34:35], v63 offset:7168
    s_waitcnt lgkmcnt(3)
    v_mfma_f32_32x32x16_bf16 v[4:19], v[24:27], v[20:23], v[4:19]
    s_waitcnt lgkmcnt(0)
    s_add_u32 s45, s45, 0x8000
    s_cmp_ge_u32 s45, 0x20000
    s_cselect_b32 s46, 0xfffe8000, s48
    s_cselect_b32 s45, 0, s45
    v_add_u32 v62, s46, v62
    v_add_u32 v63, s46, v63
    s_waitcnt vmcnt(4)
    s_barrier
    ds_read_b128 v[20:23], v62 offset:0
    ds_read_b64_tr_b16 v[24:25], v63 offset:0
    ds_read_b64_tr_b16 v[26:27], v63 offset:1024
    v_mfma_f32_32x32x16_bf16 v[4:19], v[32:35], v[28:31], v[4:19]
    ds_read_b128 v[28:31], v62 offset:1024
    ds_read_b64_tr_b16 v[32:33], v63 offset:2048
    ds_read_b64_tr_b16 v[34:35], v63 offset:3072
    s_waitcnt lgkmcnt(3)
    v_mfma_f32_32x32x16_bf16 v[4:19], v[24:27], v[20:23], v[4:19]
    ds_read_b128 v[20:23], v62 offset:2048
    ds_read_b64_tr_b16 v[24:25], v63 offset:4096
    ds_read_b64_tr_b16 v[26:27], v63 offset:5120
    s_waitcnt lgkmcnt(3)
    v_mfma_f32_32x32x16_bf16 v[4:19], v[32:35], v[28:31], v[4:19]
    ds_read_b128 v[28:31], v62 offset:3072
    ds_read_b64_tr_b16 v[32:33], v63 offset:6144
    ds_read_b64_tr_b16 v[34:35], v63 offset:7168
    s_waitcnt lgkmcnt(3)
    v_mfma_f32_32x32x16_bf16 v[4:19], v[24:27], v[20:23], v[4:19]
    s_waitcnt lgkmcnt(0)
    s_add_u32 s45, s45, 0x8000
    s_cmp_ge_u32 s45, 0x20000
    s_cselect_b32 s46, 0xfffe8000, s48
    s_cselect_b32 s45, 0, s45
    v_add_u32 v62, s46, v62
    v_add_u32 v63, s46, v63
    s_waitcnt vmcnt(0)
    s_barrier
    ds_read_b128 v[20:23], v62 offset:0
    ds_read_b64_tr_b16 v[24:25], v63 offset:0
    ds_read_b64_tr_b16 v[26:27], v63 offset:1024
    v_mfma_f32_32x32x16_bf16 v[4:19], v[32:35], v[28:31], v[4:19]
    ds_read_b128 v[28:31], v62 offset:1024
    ds_read_b64_tr_b16 v[32:33], v63 offset:2048
    ds_read_b64_tr_b16 v[34:35], v63 offset:3072
    s_waitcnt lgkmcnt(3)
    v_mfma_f32_32x32x16_bf16 v[4:19], v[24:27], v[20:23], v[4:19]
    ds_read_b128 v[20:23], v62 offset:2048
    ds_read_b64_tr_b16 v[24:25], v63 offset:4096
    ds_read_b64_tr_b16 v[26:27], v63 offset:5120
    s_waitcnt lgkmcnt(3)
    v_mfma_f32_32x32x16_bf16 v[4:19], v[32:35], v[28:31], v[4:19]
    ds_read_b128 v[28:31], v62 offset:3072
    ds_read_b64_tr_b16 v[32:33], v63 offset:6144
    ds_read_b64_tr_b16 v[34:35], v63 offset:7168
    s_waitcnt lgkmcnt(3)
    v_mfma_f32_32x32x16_bf16 v[4:19], v[24:27], v[20:23], v[4:19]
    s_waitcnt lgkmcnt(0)
    v_mfma_f32_32x32x16_bf16 v[4:19], v[32:35], v[28:31], v[4:19]
    s_nop 15
    s_nop 3
    s_barrier
    v_and_b32 v41, 31, v40
    v_lshrrev_b32 v42, 5, v40
    s_mul_i32 s37, s33, 17408
    s_mul_i32 s38, s35, 8704
    s_add_u32 s37, s37, s38
    s_lshl_b32 s38, s36, 7
    s_add_u32 s37, s37, s38
    v_mul_u32_u24 v41, 272, v41
    v_lshl_add_u32 v41, v42, 4, v41
    v_add_u32 v41, s37, v41
    ds_write_b128 v41, v[4:7] offset:0
    ds_write_b128 v41, v[8:11] offset:32
    ds_write_b128 v41, v[12:15] offset:64
    ds_write_b128 v41, v[16:19] offset:96
    s_waitcnt lgkmcnt(0)
    s_barrier
    ds_read_b128 v[4:7], v61 offset:0
    ds_read_b128 v[8:11], v61 offset:16
    ds_read_b128 v[12:15], v61 offset:17408
    ds_read_b128 v[16:19], v61 offset:17424
    s_waitcnt lgkmcnt(0)
    v_add_f32 v4, v4, v12
    v_lshlrev_b32 v42, 16, v48
    v_fma_f32 v4, v4, v52, v42
    v_add_f32 v5, v5, v13
    v_and_b32 v42, 0xffff0000, v48
    v_fma_f32 v5, v5, v53, v42
    v_add_f32 v6, v6, v14
    v_lshlrev_b32 v42, 16, v49
    v_fma_f32 v6, v6, v54, v42
    v_add_f32 v7, v7, v15
    v_and_b32 v42, 0xffff0000, v49
    v_fma_f32 v7, v7, v55, v42
    v_add_f32 v8, v8, v16
    v_lshlrev_b32 v42, 16, v50
    v_fma_f32 v8, v8, v56, v42
    v_add_f32 v9, v9, v17
    v_and_b32 v42, 0xffff0000, v50
    v_fma_f32 v9, v9, v57, v42
    v_add_f32 v10, v10, v18
    v_lshlrev_b32 v42, 16, v51
    v_fma_f32 v10, v10, v58, v42
    v_add_f32 v11, v11, v19
    v_and_b32 v42, 0xffff0000, v51
    v_fma_f32 v11, v11, v59, v42
    v_cvt_pk_bf16_f32 v48, v4, v5
    v_cvt_pk_bf16_f32 v49, v6, v7
    v_cvt_pk_bf16_f32 v50, v8, v9
    v_cvt_pk_bf16_f32 v51, v10, v11
    buffer_store_dwordx4 v[48:51], v60, s[16:19], 0 offen sc1
    v_and_b32 v41, 31, v40
    v_lshrrev_b32 v42, 5, v40
    s_mul_i32 s37, s35, 32
    s_add_u32 s37, s37, s40
    s_mul_i32 s38, s36, 32
    s_add_u32 s38, s38, s42
    s_mov_b32 s39, 1024
    s_endpgm
down_kernel_end:
    s_endpgm
.section .rodata,"a"
.p2align 6
.amdhsa_kernel mod_kernel
  .amdhsa_next_free_vgpr 56
  .amdhsa_next_free_sgpr 100
  .amdhsa_accum_offset 56
  .amdhsa_group_segment_fixed_size 0
  .amdhsa_kernarg_size 120
  .amdhsa_user_sgpr_count 2
  .amdhsa_user_sgpr_kernarg_segment_ptr 1
  .amdhsa_system_sgpr_workgroup_id_x 1
.end_amdhsa_kernel
.section .rodata,"a"
.p2align 6
.amdhsa_kernel kvprep_kernel
  .amdhsa_next_free_vgpr 252
  .amdhsa_next_free_sgpr 100
  .amdhsa_accum_offset 252
  .amdhsa_group_segment_fixed_size 0
  .amdhsa_kernarg_size 120
  .amdhsa_user_sgpr_count 2
  .amdhsa_user_sgpr_kernarg_segment_ptr 1
  .amdhsa_system_sgpr_workgroup_id_x 1
.end_amdhsa_kernel
.section .rodata,"a"
.p2align 6
.amdhsa_kernel attn_kernel
  .amdhsa_next_free_vgpr 252
  .amdhsa_next_free_sgpr 100
  .amdhsa_accum_offset 252
  .amdhsa_group_segment_fixed_size 0
  .amdhsa_kernarg_size 120
  .amdhsa_user_sgpr_count 2
  .amdhsa_user_sgpr_kernarg_segment_ptr 1
  .amdhsa_system_sgpr_workgroup_id_x 1
.end_amdhsa_kernel
.section .rodata,"a"
.p2align 6
.amdhsa_kernel oproj_kernel
  .amdhsa_next_free_vgpr 75
  .amdhsa_next_free_sgpr 100
  .amdhsa_accum_offset 76
  .amdhsa_group_segment_fixed_size 0
  .amdhsa_kernarg_size 120
  .amdhsa_user_sgpr_count 2
  .amdhsa_user_sgpr_kernarg_segment_ptr 1
  .amdhsa_system_sgpr_workgroup_id_x 1
.end_amdhsa_kernel
.section .rodata,"a"
.p2align 6
.amdhsa_kernel ln2_kernel
  .amdhsa_next_free_vgpr 76
  .amdhsa_next_free_sgpr 100
  .amdhsa_accum_offset 76
  .amdhsa_group_segment_fixed_size 0
  .amdhsa_kernarg_size 120
  .amdhsa_user_sgpr_count 2
  .amdhsa_user_sgpr_kernarg_segment_ptr 1
  .amdhsa_system_sgpr_workgroup_id_x 1
.end_amdhsa_kernel
.section .rodata,"a"
.p2align 6
.amdhsa_kernel glu_kernel
  .amdhsa_next_free_vgpr 116
  .amdhsa_next_free_sgpr 100
  .amdhsa_accum_offset 116
  .amdhsa_group_segment_fixed_size 0
  .amdhsa_kernarg_size 120
  .amdhsa_user_sgpr_count 2
  .amdhsa_user_sgpr_kernarg_segment_ptr 1
  .amdhsa_system_sgpr_workgroup_id_x 1
.end_amdhsa_kernel
.section .rodata,"a"
.p2align 6
.amdhsa_kernel down_kernel
  .amdhsa_next_free_vgpr 64
  .amdhsa_next_free_sgpr 100
  .amdhsa_accum_offset 64
  .amdhsa_group_segment_fixed_size 0
  .amdhsa_kernarg_size 120
  .amdhsa_user_sgpr_count 2
  .amdhsa_user_sgpr_kernarg_segment_ptr 1
  .amdhsa_system_sgpr_workgroup_id_x 1
.end_amdhsa_kernel
```
